```python
import torch

def _softmax(x, axis=-1):
    return torch.softmax(x, dim=axis)
def _gelu(x):
    return torch.nn.functional.gelu(x, approximate="tanh")
def _silu(x):
    return torch.nn.functional.silu(x)
def _sigmoid(x):
    return torch.sigmoid(x)
def _layernorm(x, axis=-1, eps=1e-5):
    m = x.mean(dim=axis, keepdim=True)
    v = x.var(dim=axis, keepdim=True, unbiased=False)
    return (x - m) / torch.sqrt(v + eps)
def _scatter_add(tgt, idx, src, axis=0):
    return tgt.clone().index_add_(axis, idx, src)
def _segment_sum(src, seg, n):
    out = torch.zeros((n,) + src.shape[1:], dtype=src.dtype)
    return out.index_add_(0, seg, src)
def _pad(x, pw):
    flat = tuple(v for pair in reversed(pw) for v in pair)
    return torch.nn.functional.pad(x, flat)

kernel_name = 'concat_heads__mha_block_cached__gqa_block_cached__near_ridge'

def setup_inputs():

    _w = (lambda a: (lambda t: t.to(torch.bfloat16) if t.is_floating_point() else t)(torch.as_tensor(a)))
    def _A_setup():
        B, Sq, D = 8, 96, 1024
        H, Sk, Dh = 32, 512, 128
        return {
            "x": _w((lambda *s: torch.randn(*s, dtype=torch.bfloat16) * 0.8)(B, Sq, D)),
            "k_cache": _w((lambda *s: torch.randn(*s, dtype=torch.bfloat16) * 0.8)(B, H, Sk, Dh)),
            "v_cache": _w((lambda *s: torch.randn(*s, dtype=torch.bfloat16) * 0.05)(B, H, Sk, Dh)),
            "wq": _w((lambda *s: torch.randn(*s, dtype=torch.bfloat16) * 0.8)(D, H * Dh) * (D ** -0.5)),
            "wo": _w((lambda *s: torch.randn(*s, dtype=torch.bfloat16) * 0.05)(H * Dh, D) * ((H * Dh) ** -0.5)),
        }
    _A_in = _A_setup()

    def _B_setup():
        B, Sq, D = 8, 96, 1024
        Hq, Hkv, Sk, Dh = 32, 32, 512, 128
        assert Hq % Hkv == 0, (Hq, Hkv)
        return {
            "x": _w((lambda *s: torch.randn(*s, dtype=torch.bfloat16) * 0.8)(B, Sq, D)),
            "k_cache": _w((lambda *s: torch.randn(*s, dtype=torch.bfloat16) * 0.8)(B, Hkv, Sk, Dh)),
            "v_cache": _w((lambda *s: torch.randn(*s, dtype=torch.bfloat16) * 0.05)(B, Hkv, Sk, Dh)),
            "wq": _w((lambda *s: torch.randn(*s, dtype=torch.bfloat16) * 0.8)(D, Hq * Dh) * (D ** -0.5)),
            "wo": _w((lambda *s: torch.randn(*s, dtype=torch.bfloat16) * 0.05)(Hq * Dh, D) * ((Hq * Dh) ** -0.5)),
        }
    _B_in = _B_setup()

    return {
        "A_x": _A_in["x"],
        "A_k_cache": _A_in["k_cache"],
        "A_v_cache": _A_in["v_cache"],
        "A_wq": _A_in["wq"],
        "A_wo": _A_in["wo"],
        "B_x": _B_in["x"],
        "B_k_cache": _B_in["k_cache"],
        "B_v_cache": _B_in["v_cache"],
        "B_wq": _B_in["wq"],
        "B_wo": _B_in["wo"],
    }

def reference(A_x, A_k_cache, A_v_cache, A_wq, A_wo, B_x, B_k_cache, B_v_cache, B_wq, B_wo):
    def _A_ref(x, k_cache, v_cache, wq, wo):
        B, Sq, D = x.shape
        H, Dh = 32, 128
        q = (lambda x, *d: x.permute(*d))((x @ wq).reshape(B, Sq, H, Dh), 0, 2, 1, 3)
        scores = torch.einsum("bhqd,bhkd->bhqk", q, k_cache) * (Dh ** -0.5)
        p = _softmax(scores, axis=-1)
        o = torch.einsum("bhqk,bhkd->bhqd", p, v_cache)
        return (lambda x, *d: x.permute(*d))(o, 0, 2, 1, 3).reshape(B, Sq, H * Dh) @ wo

    def _B_ref(x, k_cache, v_cache, wq, wo):
        B, Sq, D = x.shape
        Hq, Dh = 32, 128
        Hkv = k_cache.shape[1]
        rep = Hq // Hkv
        q = (lambda x, *d: x.permute(*d))((x @ wq).reshape(B, Sq, Hq, Dh), 0, 2, 1, 3)
        k = (lambda x, n, axis: torch.repeat_interleave(x, n, dim=axis))(k_cache, rep, axis=1)
        v = (lambda x, n, axis: torch.repeat_interleave(x, n, dim=axis))(v_cache, rep, axis=1)
        scores = torch.einsum("bhqd,bhkd->bhqk", q, k) * (Dh ** -0.5)
        p = _softmax(scores, axis=-1)
        o = torch.einsum("bhqk,bhkd->bhqd", p, v)
        return (lambda x, *d: x.permute(*d))(o, 0, 2, 1, 3).reshape(B, Sq, Hq * Dh) @ wo

    a = _A_ref(A_x, A_k_cache, A_v_cache, A_wq, A_wo)
    b = _B_ref(B_x, B_k_cache, B_v_cache, B_wq, B_wo)
    return torch.concatenate([a, b], axis=-1)
```

```asm
; @launch grid=(256,1,1) block=(512,1,1) lds=163840
.amdgcn_target "amdgcn-amd-amdhsa--gfx950"
.text
.globl concat_heads__mha_block_cached__gqa_block_cached__near_ridge_kernel
.p2align 8
.type concat_heads__mha_block_cached__gqa_block_cached__near_ridge_kernel,@function
concat_heads__mha_block_cached__gqa_block_cached__near_ridge_kernel:
    s_cmp_ge_u32 s2, 256
    s_cbranch_scc1 L_exit
    s_bfe_u32 s52, s2, 0x10002
    s_mul_i32 s60, s52, 40
    s_load_dwordx8 s[4:11], s[0:1], s60
    s_add_u32 s61, s60, 32
    s_load_dwordx2 s[12:13], s[0:1], s61
    s_load_dwordx4 s[16:19], s[0:1], 88
    s_load_dwordx2 s[14:15], s[0:1], 80
    v_lshrrev_b32 v1, 6, v0
    v_and_b32_e64 v0, 63, v0
    s_and_b32 s53, s2, 3
    v_readfirstlane_b32 s3, v1
    s_bfe_u32 s54, s2, 0x30003
    s_lshr_b32 s55, s2, 6
    s_lshr_b32 s58, s54, 1
    s_xor_b32 s58, s58, s53
    s_lshl_b32 s58, s58, 3
    s_add_u32 s58, s58, s54
    s_and_b32 s57, s3, 3
    s_mul_i32 s69, s57, 6144
    s_lshl_b32 s70, s57, 12
    s_cmp_lt_u32 s3, 4
    s_cbranch_scc1 L_compute
    v_lshrrev_b32 v1, 4, v0
    v_and_b32 v2, 15, v0
    v_lshrrev_b32 v3, 3, v0
    v_and_b32_e64 v4, 7, v0
    s_mul_i32 s60, s55, 192
    s_mul_i32 s61, s57, 48
    s_add_u32 s60, s60, s61
    s_lshl_b32 s60, s60, 11
    v_lshl_add_u32 v5, v3, 11, s60
    v_xor_b32 v6, v4, v1
    v_lshl_add_u32 v8, v6, 4, v5
    v_xor_b32_e64 v6, 4, v6
    v_lshl_add_u32 v7, v6, 4, v5
    v_add_u32 v9, 15360, v7
    v_add_u32 v10, 30720, v8
    v_add_u32 v11, 46080, v7
    v_add_u32 v12, 65536, v8
    v_add_u32 v13, 80896, v7
    s_lshl_b32 s60, s57, 17
    s_lshl_b32 s61, s58, 8
    s_add_u32 s60, s60, s61
    v_lshl_add_u32 v5, v1, 13, s60
    v_lshlrev_b32 v6, 1, v1
    v_xor_b32_e64 v6, v6, v2
    v_lshl_add_u32 v14, v6, 4, v5
    v_xor_b32_e64 v7, 8, v6
    v_lshl_add_u32 v7, v7, 4, v5
    v_add_u32 v15, 31744, v14
    v_add_u32 v16, 63488, v7
    v_add_u32 v17, 95232, v7
    s_lshr_b32 s71, s54, 1
    s_add_u32 s71, s71, s55
    s_and_b32 s71, s71, 3
    s_lshl_b32 s71, s71, 2
    v_bfe_u32 v7, v0, 1, 4
    v_and_b32 v5, 1, v0
    v_lshlrev_b32 v5, 7, v5
    v_lshl_add_u32 v33, v7, 11, v5
    v_lshl_add_u32 v32, v7, 13, v5
    v_add_u32 v32, s60, v32
    s_waitcnt lgkmcnt(0)
    s_mov_b32 s32, s10
    s_mov_b32 s33, s11
    s_mov_b32 s34, 8388608
    s_mov_b32 s35, 0x20000
    s_mov_b32 s20, s4
    s_mov_b32 s21, s5
    s_mov_b32 s22, 1572864
    s_mov_b32 s23, 0x20000
    s_add_u32 s60, s71, 0
    s_add_u32 m0, s70, 0
    s_and_b32 s60, s60, 15
    s_lshr_b32 s61, s60, 2
    s_xor_b32 s60, s60, s61
    s_lshl_b32 s61, s60, 19
    buffer_load_dwordx4 v14, s[32:35], s61 offen offset:0  lds
    buffer_load_dwordx4 v15, s[32:35], s61 offen offset:1024  lds
    buffer_load_dwordx4 v16, s[32:35], s61 offen offset:2048  lds
    buffer_load_dwordx4 v17, s[32:35], s61 offen offset:3072  lds
    s_add_u32 m0, s69, 65536
    s_lshl_b32 s60, s60, 7
    buffer_load_dwordx4 v8, s[20:23], s60 offen offset:0  lds
    buffer_load_dwordx4 v9, s[20:23], s60 offen offset:1024  lds
    buffer_load_dwordx4 v10, s[20:23], s60 offen offset:2048  lds
    buffer_load_dwordx4 v11, s[20:23], s60 offen offset:3072  lds
    s_add_u32 m0, s69, 69632
    s_nop 0
    buffer_load_dwordx4 v12, s[20:23], s60 offen offset:0  lds
    buffer_load_dwordx4 v13, s[20:23], s60 offen offset:1024  lds
    s_add_u32 s60, s71, 1
    s_add_u32 m0, s70, 16384
    s_and_b32 s60, s60, 15
    s_lshr_b32 s61, s60, 2
    s_xor_b32 s60, s60, s61
    s_lshl_b32 s61, s60, 19
    buffer_load_dwordx4 v14, s[32:35], s61 offen offset:0  lds
    buffer_load_dwordx4 v15, s[32:35], s61 offen offset:1024  lds
    buffer_load_dwordx4 v16, s[32:35], s61 offen offset:2048  lds
    buffer_load_dwordx4 v17, s[32:35], s61 offen offset:3072  lds
    s_add_u32 m0, s69, 90112
    s_lshl_b32 s60, s60, 7
    buffer_load_dwordx4 v8, s[20:23], s60 offen offset:0  lds
    buffer_load_dwordx4 v9, s[20:23], s60 offen offset:1024  lds
    buffer_load_dwordx4 v10, s[20:23], s60 offen offset:2048  lds
    buffer_load_dwordx4 v11, s[20:23], s60 offen offset:3072  lds
    s_add_u32 m0, s69, 94208
    s_nop 0
    buffer_load_dwordx4 v12, s[20:23], s60 offen offset:0  lds
    buffer_load_dwordx4 v13, s[20:23], s60 offen offset:1024  lds
    s_mov_b32 s24, s6
    s_mov_b32 s25, s7
    s_mov_b32 s26, 33554432
    s_mov_b32 s27, 0x20000
    s_mov_b32 s28, s8
    s_mov_b32 s29, s9
    s_mov_b32 s30, 33554432
    s_mov_b32 s31, 0x20000
    s_mov_b32 s36, s12
    s_mov_b32 s37, s13
    s_mov_b32 s38, 8388608
    s_mov_b32 s39, 0x20000
    s_mov_b32 s44, s18
    s_mov_b32 s45, s19
    s_mov_b32 s46, 268435456
    s_mov_b32 s47, 0x20000
    s_mul_i32 s56, s55, 2
    s_add_u32 s56, s56, s54
    s_and_b32 s56, s56, 7
    s_xor_b32 s56, s56, s52
    s_lshl_b32 s56, s56, 2
    s_lshr_b32 s56, 1935823168, s56
    s_and_b32 s56, s56, 7
    s_and_b32 s76, s2, 7
    s_lshl_b32 s61, s55, 3
    s_add_u32 s76, s76, s61
    s_lshr_b32 s60, s57, 1
    s_lshl_b32 s61, s55, 1
    s_add_u32 s60, s60, s61
    s_lshl_b32 s60, s60, 5
    s_add_u32 s60, s60, s58
    s_lshl_b32 s60, s60, 17
    s_and_b32 s61, s57, 1
    s_lshl_b32 s61, s61, 11
    s_add_u32 s60, s60, s61
    v_lshl_add_u32 v5, v1, 8, s60
    v_xor_b32 v7, v2, v1
    v_xor_b32_e64 v3, 0, v7
    v_lshl_add_u32 v18, v3, 4, v5
    v_xor_b32_e64 v3, 4, v7
    v_lshl_add_u32 v19, v3, 4, v5
    v_add_u32 v19, 7168, v19
    v_xor_b32_e64 v3, 8, v7
    v_lshl_add_u32 v20, v3, 4, v5
    v_add_u32 v20, 14336, v20
    v_xor_b32_e64 v3, 12, v7
    v_lshl_add_u32 v21, v3, 4, v5
    v_add_u32 v21, 21504, v21
    v_lshl_add_u32 v22, v6, 4, v5
    v_xor_b32_e64 v7, 8, v6
    v_lshl_add_u32 v23, v7, 4, v5
    v_add_u32 v34, 14336, v22
    v_add_u32 v35, 21504, v23
    v_add_u32 v23, 7168, v23
    s_mov_b32 s60, 0
    s_lshl_b32 s61, s57, 15
    s_add_u32 s60, s60, s61
    s_lshl_b32 s61, s56, 8
    s_add_u32 s60, s60, s61
    v_lshl_add_u32 v5, v1, 11, s60
    v_add_u32 v33, s60, v33
    v_lshl_add_u32 v24, v6, 4, v5
    v_lshl_add_u32 v7, v7, 4, v5
    v_add_u32 v25, 7168, v7
    v_add_u32 v26, 14336, v24
    v_add_u32 v27, 21504, v7
    s_mul_i32 s60, s76, 393216
    s_add_u32 s60, s60, s69
    v_lshl_add_u32 v28, v0, 4, s60
    s_lshl_b32 s60, s2, 11
    s_lshl_b32 s61, s57, 9
    s_add_u32 s60, s60, s61
    s_add_u32 s60, s60, 50331648
    v_lshl_add_u32 v29, v4, 2, s60
    s_lshl_b32 s72, s54, 1
    s_add_u32 s60, s70, 65536
    v_lshl_add_u32 v1, v0, 4, s60
    v_add_u32 v2, 49152, v1
    s_bitcmp0_b32 s2, 3
    s_cbranch_scc1 L_late
    s_waitcnt vmcnt(10)
    s_barrier
    s_add_u32 s60, s71, 2
    s_add_u32 m0, s70, 32768
    s_and_b32 s60, s60, 15
    s_lshr_b32 s61, s60, 2
    s_xor_b32 s60, s60, s61
    s_lshl_b32 s61, s60, 19
    buffer_load_dwordx4 v14, s[32:35], s61 offen offset:0  lds
    buffer_load_dwordx4 v15, s[32:35], s61 offen offset:1024  lds
    buffer_load_dwordx4 v16, s[32:35], s61 offen offset:2048  lds
    buffer_load_dwordx4 v17, s[32:35], s61 offen offset:3072  lds
    s_add_u32 m0, s69, 114688
    s_lshl_b32 s60, s60, 7
    buffer_load_dwordx4 v8, s[20:23], s60 offen offset:0  lds
    buffer_load_dwordx4 v9, s[20:23], s60 offen offset:1024  lds
    buffer_load_dwordx4 v10, s[20:23], s60 offen offset:2048  lds
    buffer_load_dwordx4 v11, s[20:23], s60 offen offset:3072  lds
    s_add_u32 m0, s69, 118784
    s_nop 0
    buffer_load_dwordx4 v12, s[20:23], s60 offen offset:0  lds
    buffer_load_dwordx4 v13, s[20:23], s60 offen offset:1024  lds
    s_add_u32 s60, s71, 3
    s_add_u32 m0, s70, 49152
    s_and_b32 s60, s60, 15
    s_lshr_b32 s61, s60, 2
    s_xor_b32 s60, s60, s61
    s_lshl_b32 s61, s60, 19
    buffer_load_dwordx4 v14, s[32:35], s61 offen offset:0  lds
    buffer_load_dwordx4 v15, s[32:35], s61 offen offset:1024  lds
    buffer_load_dwordx4 v16, s[32:35], s61 offen offset:2048  lds
    buffer_load_dwordx4 v17, s[32:35], s61 offen offset:3072  lds
    s_add_u32 m0, s69, 139264
    s_lshl_b32 s60, s60, 7
    buffer_load_dwordx4 v8, s[20:23], s60 offen offset:0  lds
    buffer_load_dwordx4 v9, s[20:23], s60 offen offset:1024  lds
    buffer_load_dwordx4 v10, s[20:23], s60 offen offset:2048  lds
    buffer_load_dwordx4 v11, s[20:23], s60 offen offset:3072  lds
    s_add_u32 m0, s69, 143360
    s_nop 0
    buffer_load_dwordx4 v12, s[20:23], s60 offen offset:0  lds
    buffer_load_dwordx4 v13, s[20:23], s60 offen offset:1024  lds
    s_waitcnt vmcnt(20)
    s_barrier
    s_add_u32 s60, s71, 4
    s_add_u32 m0, s70, 0
    s_and_b32 s60, s60, 15
    s_lshr_b32 s61, s60, 2
    s_xor_b32 s60, s60, s61
    s_lshl_b32 s61, s60, 19
    buffer_load_dwordx4 v14, s[32:35], s61 offen offset:0  lds
    buffer_load_dwordx4 v15, s[32:35], s61 offen offset:1024  lds
    buffer_load_dwordx4 v16, s[32:35], s61 offen offset:2048  lds
    buffer_load_dwordx4 v17, s[32:35], s61 offen offset:3072  lds
    s_add_u32 m0, s69, 65536
    s_lshl_b32 s60, s60, 7
    buffer_load_dwordx4 v8, s[20:23], s60 offen offset:0  lds
    buffer_load_dwordx4 v9, s[20:23], s60 offen offset:1024  lds
    buffer_load_dwordx4 v10, s[20:23], s60 offen offset:2048  lds
    buffer_load_dwordx4 v11, s[20:23], s60 offen offset:3072  lds
    s_add_u32 m0, s69, 69632
    s_nop 0
    buffer_load_dwordx4 v12, s[20:23], s60 offen offset:0  lds
    buffer_load_dwordx4 v13, s[20:23], s60 offen offset:1024  lds
    s_waitcnt vmcnt(20)
    s_barrier
    s_add_u32 s60, s71, 5
    s_add_u32 m0, s70, 16384
    s_and_b32 s60, s60, 15
    s_lshr_b32 s61, s60, 2
    s_xor_b32 s60, s60, s61
    s_lshl_b32 s61, s60, 19
    buffer_load_dwordx4 v14, s[32:35], s61 offen offset:0  lds
    buffer_load_dwordx4 v15, s[32:35], s61 offen offset:1024  lds
    buffer_load_dwordx4 v16, s[32:35], s61 offen offset:2048  lds
    buffer_load_dwordx4 v17, s[32:35], s61 offen offset:3072  lds
    s_add_u32 m0, s69, 90112
    s_lshl_b32 s60, s60, 7
    buffer_load_dwordx4 v8, s[20:23], s60 offen offset:0  lds
    buffer_load_dwordx4 v9, s[20:23], s60 offen offset:1024  lds
    buffer_load_dwordx4 v10, s[20:23], s60 offen offset:2048  lds
    buffer_load_dwordx4 v11, s[20:23], s60 offen offset:3072  lds
    s_add_u32 m0, s69, 94208
    s_nop 0
    buffer_load_dwordx4 v12, s[20:23], s60 offen offset:0  lds
    buffer_load_dwordx4 v13, s[20:23], s60 offen offset:1024  lds
    s_mov_b32 s60, 0
    buffer_load_dwordx4 v[36:39], v18, s[24:27], s60 offen offset:0 nt
    buffer_load_dwordx4 v[40:43], v19, s[24:27], s60 offen offset:1024 nt
    buffer_load_dwordx4 v[44:47], v20, s[24:27], s60 offen offset:2048 nt
    buffer_load_dwordx4 v[48:51], v21, s[24:27], s60 offen offset:3072 nt
    s_mov_b32 s60, 4096
    buffer_load_dwordx4 v[52:55], v18, s[24:27], s60 offen offset:0 nt
    buffer_load_dwordx4 v[56:59], v19, s[24:27], s60 offen offset:1024 nt
    buffer_load_dwordx4 v[60:63], v20, s[24:27], s60 offen offset:2048 nt
    buffer_load_dwordx4 v[64:67], v21, s[24:27], s60 offen offset:3072 nt
    s_mov_b32 s60, 0
    buffer_load_dwordx4 v[68:71], v22, s[28:31], s60 offen offset:0 nt
    buffer_load_dwordx4 v[72:75], v23, s[28:31], s60 offen offset:1024 nt
    buffer_load_dwordx4 v[76:79], v34, s[28:31], s60 offen offset:2048 nt
    buffer_load_dwordx4 v[80:83], v35, s[28:31], s60 offen offset:3072 nt
    s_mov_b32 s60, 1024
    buffer_load_dwordx4 v[84:87], v18, s[24:27], s60 offen offset:0 nt
    buffer_load_dwordx4 v[88:91], v19, s[24:27], s60 offen offset:1024 nt
    buffer_load_dwordx4 v[92:95], v20, s[24:27], s60 offen offset:2048 nt
    buffer_load_dwordx4 v[96:99], v21, s[24:27], s60 offen offset:3072 nt
    s_mov_b32 s60, 4096
    buffer_load_dwordx4 v[100:103], v22, s[28:31], s60 offen offset:0 nt
    buffer_load_dwordx4 v[104:107], v23, s[28:31], s60 offen offset:1024 nt
    buffer_load_dwordx4 v[108:111], v34, s[28:31], s60 offen offset:2048 nt
    buffer_load_dwordx4 v[112:115], v35, s[28:31], s60 offen offset:3072 nt
    s_mov_b32 s60, 5120
    buffer_load_dwordx4 v[116:119], v18, s[24:27], s60 offen offset:0 nt
    buffer_load_dwordx4 v[120:123], v19, s[24:27], s60 offen offset:1024 nt
    buffer_load_dwordx4 v[124:127], v20, s[24:27], s60 offen offset:2048 nt
    buffer_load_dwordx4 v[128:131], v21, s[24:27], s60 offen offset:3072 nt
    s_mov_b32 s60, 1024
    buffer_load_dwordx4 v[132:135], v22, s[28:31], s60 offen offset:0 nt
    buffer_load_dwordx4 v[136:139], v23, s[28:31], s60 offen offset:1024 nt
    s_waitcnt vmcnt(55)
    buffer_load_dwordx4 v[140:143], v34, s[28:31], s60 offen offset:2048 nt
    s_waitcnt vmcnt(55)
    buffer_load_dwordx4 v[144:147], v35, s[28:31], s60 offen offset:3072 nt
    s_mov_b32 s60, 32768
    s_waitcnt vmcnt(55)
    buffer_load_dwordx4 v[148:151], v18, s[24:27], s60 offen offset:0 nt
    s_waitcnt vmcnt(55)
    buffer_load_dwordx4 v[152:155], v19, s[24:27], s60 offen offset:1024 nt
    s_waitcnt vmcnt(55)
    buffer_load_dwordx4 v[156:159], v20, s[24:27], s60 offen offset:2048 nt
    s_waitcnt vmcnt(55)
    buffer_load_dwordx4 v[160:163], v21, s[24:27], s60 offen offset:3072 nt
    s_mov_b32 s60, 5120
    s_waitcnt vmcnt(55)
    buffer_load_dwordx4 v[164:167], v22, s[28:31], s60 offen offset:0 nt
    s_waitcnt vmcnt(55)
    buffer_load_dwordx4 v[168:171], v23, s[28:31], s60 offen offset:1024 nt
    s_waitcnt vmcnt(55)
    buffer_load_dwordx4 v[172:175], v34, s[28:31], s60 offen offset:2048 nt
    s_waitcnt vmcnt(55)
    buffer_load_dwordx4 v[176:179], v35, s[28:31], s60 offen offset:3072 nt
    s_mov_b32 s60, 36864
    s_waitcnt vmcnt(55)
    buffer_load_dwordx4 v[180:183], v18, s[24:27], s60 offen offset:0 nt
    s_waitcnt vmcnt(55)
    buffer_load_dwordx4 v[184:187], v19, s[24:27], s60 offen offset:1024 nt
    s_waitcnt vmcnt(55)
    buffer_load_dwordx4 v[188:191], v20, s[24:27], s60 offen offset:2048 nt
    s_waitcnt vmcnt(55)
    buffer_load_dwordx4 v[192:195], v21, s[24:27], s60 offen offset:3072 nt
    s_mov_b32 s60, 32768
    s_waitcnt vmcnt(55)
    buffer_load_dwordx4 v[196:199], v22, s[28:31], s60 offen offset:0 nt
    s_waitcnt vmcnt(55)
    buffer_load_dwordx4 v[200:203], v23, s[28:31], s60 offen offset:1024 nt
    s_waitcnt vmcnt(55)
    buffer_load_dwordx4 v[204:207], v34, s[28:31], s60 offen offset:2048 nt
    s_waitcnt vmcnt(55)
    buffer_load_dwordx4 v[208:211], v35, s[28:31], s60 offen offset:3072 nt
    s_barrier
    s_add_u32 s60, s71, 6
    s_add_u32 m0, s70, 32768
    s_and_b32 s60, s60, 15
    s_lshr_b32 s61, s60, 2
    s_xor_b32 s60, s60, s61
    s_lshl_b32 s61, s60, 19
    s_waitcnt vmcnt(55)
    buffer_load_dwordx4 v14, s[32:35], s61 offen offset:0  lds
    s_waitcnt vmcnt(55)
    buffer_load_dwordx4 v15, s[32:35], s61 offen offset:1024  lds
    s_waitcnt vmcnt(55)
    buffer_load_dwordx4 v16, s[32:35], s61 offen offset:2048  lds
    s_waitcnt vmcnt(55)
    buffer_load_dwordx4 v17, s[32:35], s61 offen offset:3072  lds
    s_add_u32 m0, s69, 114688
    s_lshl_b32 s60, s60, 7
    s_waitcnt vmcnt(55)
    buffer_load_dwordx4 v8, s[20:23], s60 offen offset:0  lds
    s_waitcnt vmcnt(55)
    buffer_load_dwordx4 v9, s[20:23], s60 offen offset:1024  lds
    s_waitcnt vmcnt(55)
    buffer_load_dwordx4 v10, s[20:23], s60 offen offset:2048  lds
    s_waitcnt vmcnt(55)
    buffer_load_dwordx4 v11, s[20:23], s60 offen offset:3072  lds
    s_add_u32 m0, s69, 118784
    s_waitcnt vmcnt(55)
    buffer_load_dwordx4 v12, s[20:23], s60 offen offset:0  lds
    s_waitcnt vmcnt(55)
    buffer_load_dwordx4 v13, s[20:23], s60 offen offset:1024  lds
    s_barrier
    s_add_u32 s60, s71, 7
    s_add_u32 m0, s70, 49152
    s_and_b32 s60, s60, 15
    s_lshr_b32 s61, s60, 2
    s_xor_b32 s60, s60, s61
    s_lshl_b32 s61, s60, 19
    s_waitcnt vmcnt(55)
    buffer_load_dwordx4 v14, s[32:35], s61 offen offset:0  lds
    s_waitcnt vmcnt(55)
    buffer_load_dwordx4 v15, s[32:35], s61 offen offset:1024  lds
    s_waitcnt vmcnt(55)
    buffer_load_dwordx4 v16, s[32:35], s61 offen offset:2048  lds
    s_waitcnt vmcnt(55)
    buffer_load_dwordx4 v17, s[32:35], s61 offen offset:3072  lds
    s_add_u32 m0, s69, 139264
    s_lshl_b32 s60, s60, 7
    s_waitcnt vmcnt(55)
    buffer_load_dwordx4 v8, s[20:23], s60 offen offset:0  lds
    s_waitcnt vmcnt(55)
    buffer_load_dwordx4 v9, s[20:23], s60 offen offset:1024  lds
    s_waitcnt vmcnt(55)
    buffer_load_dwordx4 v10, s[20:23], s60 offen offset:2048  lds
    s_waitcnt vmcnt(55)
    buffer_load_dwordx4 v11, s[20:23], s60 offen offset:3072  lds
    s_add_u32 m0, s69, 143360
    s_waitcnt vmcnt(55)
    buffer_load_dwordx4 v12, s[20:23], s60 offen offset:0  lds
    s_waitcnt vmcnt(55)
    buffer_load_dwordx4 v13, s[20:23], s60 offen offset:1024  lds
    s_barrier
    s_add_u32 s60, s71, 8
    s_add_u32 m0, s70, 0
    s_and_b32 s60, s60, 15
    s_lshr_b32 s61, s60, 2
    s_xor_b32 s60, s60, s61
    s_lshl_b32 s61, s60, 19
    s_waitcnt vmcnt(55)
    buffer_load_dwordx4 v14, s[32:35], s61 offen offset:0  lds
    s_waitcnt vmcnt(55)
    buffer_load_dwordx4 v15, s[32:35], s61 offen offset:1024  lds
    s_waitcnt vmcnt(55)
    buffer_load_dwordx4 v16, s[32:35], s61 offen offset:2048  lds
    s_waitcnt vmcnt(55)
    buffer_load_dwordx4 v17, s[32:35], s61 offen offset:3072  lds
    s_add_u32 m0, s69, 65536
    s_lshl_b32 s60, s60, 7
    s_waitcnt vmcnt(55)
    buffer_load_dwordx4 v8, s[20:23], s60 offen offset:0  lds
    s_waitcnt vmcnt(55)
    buffer_load_dwordx4 v9, s[20:23], s60 offen offset:1024  lds
    s_waitcnt vmcnt(55)
    buffer_load_dwordx4 v10, s[20:23], s60 offen offset:2048  lds
    s_waitcnt vmcnt(55)
    buffer_load_dwordx4 v11, s[20:23], s60 offen offset:3072  lds
    s_add_u32 m0, s69, 69632
    s_waitcnt vmcnt(55)
    buffer_load_dwordx4 v12, s[20:23], s60 offen offset:0  lds
    s_waitcnt vmcnt(55)
    buffer_load_dwordx4 v13, s[20:23], s60 offen offset:1024  lds
    s_waitcnt vmcnt(20)
    s_barrier
    s_add_u32 s60, s71, 9
    s_add_u32 m0, s70, 16384
    s_and_b32 s60, s60, 15
    s_lshr_b32 s61, s60, 2
    s_xor_b32 s60, s60, s61
    s_lshl_b32 s61, s60, 19
    buffer_load_dwordx4 v14, s[32:35], s61 offen offset:0  lds
    buffer_load_dwordx4 v15, s[32:35], s61 offen offset:1024  lds
    buffer_load_dwordx4 v16, s[32:35], s61 offen offset:2048  lds
    buffer_load_dwordx4 v17, s[32:35], s61 offen offset:3072  lds
    s_add_u32 m0, s69, 90112
    s_lshl_b32 s60, s60, 7
    buffer_load_dwordx4 v8, s[20:23], s60 offen offset:0  lds
    buffer_load_dwordx4 v9, s[20:23], s60 offen offset:1024  lds
    buffer_load_dwordx4 v10, s[20:23], s60 offen offset:2048  lds
    buffer_load_dwordx4 v11, s[20:23], s60 offen offset:3072  lds
    s_add_u32 m0, s69, 94208
    s_nop 0
    buffer_load_dwordx4 v12, s[20:23], s60 offen offset:0  lds
    buffer_load_dwordx4 v13, s[20:23], s60 offen offset:1024  lds
    s_waitcnt vmcnt(20)
    s_barrier
    s_add_u32 s60, s71, 10
    s_add_u32 m0, s70, 32768
    s_and_b32 s60, s60, 15
    s_lshr_b32 s61, s60, 2
    s_xor_b32 s60, s60, s61
    s_lshl_b32 s61, s60, 19
    buffer_load_dwordx4 v14, s[32:35], s61 offen offset:0  lds
    buffer_load_dwordx4 v15, s[32:35], s61 offen offset:1024  lds
    buffer_load_dwordx4 v16, s[32:35], s61 offen offset:2048  lds
    buffer_load_dwordx4 v17, s[32:35], s61 offen offset:3072  lds
    s_add_u32 m0, s69, 114688
    s_lshl_b32 s60, s60, 7
    buffer_load_dwordx4 v8, s[20:23], s60 offen offset:0  lds
    buffer_load_dwordx4 v9, s[20:23], s60 offen offset:1024  lds
    buffer_load_dwordx4 v10, s[20:23], s60 offen offset:2048  lds
    buffer_load_dwordx4 v11, s[20:23], s60 offen offset:3072  lds
    s_add_u32 m0, s69, 118784
    s_nop 0
    buffer_load_dwordx4 v12, s[20:23], s60 offen offset:0  lds
    buffer_load_dwordx4 v13, s[20:23], s60 offen offset:1024  lds
    s_waitcnt vmcnt(20)
    s_barrier
    s_add_u32 s60, s71, 11
    s_add_u32 m0, s70, 49152
    s_and_b32 s60, s60, 15
    s_lshr_b32 s61, s60, 2
    s_xor_b32 s60, s60, s61
    s_lshl_b32 s61, s60, 19
    buffer_load_dwordx4 v14, s[32:35], s61 offen offset:0  lds
    buffer_load_dwordx4 v15, s[32:35], s61 offen offset:1024  lds
    buffer_load_dwordx4 v16, s[32:35], s61 offen offset:2048  lds
    buffer_load_dwordx4 v17, s[32:35], s61 offen offset:3072  lds
    s_add_u32 m0, s69, 139264
    s_lshl_b32 s60, s60, 7
    buffer_load_dwordx4 v8, s[20:23], s60 offen offset:0  lds
    buffer_load_dwordx4 v9, s[20:23], s60 offen offset:1024  lds
    buffer_load_dwordx4 v10, s[20:23], s60 offen offset:2048  lds
    buffer_load_dwordx4 v11, s[20:23], s60 offen offset:3072  lds
    s_add_u32 m0, s69, 143360
    s_nop 0
    buffer_load_dwordx4 v12, s[20:23], s60 offen offset:0  lds
    buffer_load_dwordx4 v13, s[20:23], s60 offen offset:1024  lds
    s_waitcnt vmcnt(20)
    s_barrier
    s_add_u32 s60, s71, 12
    s_add_u32 m0, s70, 0
    s_and_b32 s60, s60, 15
    s_lshr_b32 s61, s60, 2
    s_xor_b32 s60, s60, s61
    s_lshl_b32 s61, s60, 19
    buffer_load_dwordx4 v14, s[32:35], s61 offen offset:0  lds
    buffer_load_dwordx4 v15, s[32:35], s61 offen offset:1024  lds
    buffer_load_dwordx4 v16, s[32:35], s61 offen offset:2048  lds
    buffer_load_dwordx4 v17, s[32:35], s61 offen offset:3072  lds
    s_add_u32 m0, s69, 65536
    s_lshl_b32 s60, s60, 7
    buffer_load_dwordx4 v8, s[20:23], s60 offen offset:0  lds
    buffer_load_dwordx4 v9, s[20:23], s60 offen offset:1024  lds
    buffer_load_dwordx4 v10, s[20:23], s60 offen offset:2048  lds
    buffer_load_dwordx4 v11, s[20:23], s60 offen offset:3072  lds
    s_add_u32 m0, s69, 69632
    s_nop 0
    buffer_load_dwordx4 v12, s[20:23], s60 offen offset:0  lds
    buffer_load_dwordx4 v13, s[20:23], s60 offen offset:1024  lds
    s_waitcnt vmcnt(20)
    s_barrier
    s_add_u32 s60, s71, 13
    s_add_u32 m0, s70, 16384
    s_and_b32 s60, s60, 15
    s_lshr_b32 s61, s60, 2
    s_xor_b32 s60, s60, s61
    s_lshl_b32 s61, s60, 19
    buffer_load_dwordx4 v14, s[32:35], s61 offen offset:0  lds
    buffer_load_dwordx4 v15, s[32:35], s61 offen offset:1024  lds
    buffer_load_dwordx4 v16, s[32:35], s61 offen offset:2048  lds
    buffer_load_dwordx4 v17, s[32:35], s61 offen offset:3072  lds
    s_add_u32 m0, s69, 90112
    s_lshl_b32 s60, s60, 7
    buffer_load_dwordx4 v8, s[20:23], s60 offen offset:0  lds
    buffer_load_dwordx4 v9, s[20:23], s60 offen offset:1024  lds
    buffer_load_dwordx4 v10, s[20:23], s60 offen offset:2048  lds
    buffer_load_dwordx4 v11, s[20:23], s60 offen offset:3072  lds
    s_add_u32 m0, s69, 94208
    s_nop 0
    buffer_load_dwordx4 v12, s[20:23], s60 offen offset:0  lds
    buffer_load_dwordx4 v13, s[20:23], s60 offen offset:1024  lds
    s_waitcnt vmcnt(20)
    s_barrier
    s_add_u32 s60, s71, 14
    s_add_u32 m0, s70, 32768
    s_and_b32 s60, s60, 15
    s_lshr_b32 s61, s60, 2
    s_xor_b32 s60, s60, s61
    s_lshl_b32 s61, s60, 19
    buffer_load_dwordx4 v14, s[32:35], s61 offen offset:0  lds
    buffer_load_dwordx4 v15, s[32:35], s61 offen offset:1024  lds
    buffer_load_dwordx4 v16, s[32:35], s61 offen offset:2048  lds
    buffer_load_dwordx4 v17, s[32:35], s61 offen offset:3072  lds
    s_add_u32 m0, s69, 114688
    s_lshl_b32 s60, s60, 7
    buffer_load_dwordx4 v8, s[20:23], s60 offen offset:0  lds
    buffer_load_dwordx4 v9, s[20:23], s60 offen offset:1024  lds
    buffer_load_dwordx4 v10, s[20:23], s60 offen offset:2048  lds
    buffer_load_dwordx4 v11, s[20:23], s60 offen offset:3072  lds
    s_add_u32 m0, s69, 118784
    s_nop 0
    buffer_load_dwordx4 v12, s[20:23], s60 offen offset:0  lds
    buffer_load_dwordx4 v13, s[20:23], s60 offen offset:1024  lds
    s_waitcnt vmcnt(20)
    s_barrier
    s_add_u32 s60, s71, 15
    s_add_u32 m0, s70, 49152
    s_and_b32 s60, s60, 15
    s_lshr_b32 s61, s60, 2
    s_xor_b32 s60, s60, s61
    s_lshl_b32 s61, s60, 19
    buffer_load_dwordx4 v14, s[32:35], s61 offen offset:0  lds
    buffer_load_dwordx4 v15, s[32:35], s61 offen offset:1024  lds
    buffer_load_dwordx4 v16, s[32:35], s61 offen offset:2048  lds
    buffer_load_dwordx4 v17, s[32:35], s61 offen offset:3072  lds
    s_add_u32 m0, s69, 139264
    s_lshl_b32 s60, s60, 7
    buffer_load_dwordx4 v8, s[20:23], s60 offen offset:0  lds
    buffer_load_dwordx4 v9, s[20:23], s60 offen offset:1024  lds
    buffer_load_dwordx4 v10, s[20:23], s60 offen offset:2048  lds
    buffer_load_dwordx4 v11, s[20:23], s60 offen offset:3072  lds
    s_add_u32 m0, s69, 143360
    s_nop 0
    buffer_load_dwordx4 v12, s[20:23], s60 offen offset:0  lds
    buffer_load_dwordx4 v13, s[20:23], s60 offen offset:1024  lds
    s_waitcnt vmcnt(20)
    s_barrier
    s_waitcnt vmcnt(10)
    s_barrier
    s_mov_b32 s60, 33792
    buffer_load_dwordx4 v[212:215], v18, s[24:27], s60 offen offset:0 nt
    ds_write_b128 v1, v[36:39] offset:0
    ds_write_b128 v1, v[40:43] offset:1024
    buffer_load_dwordx4 v[216:219], v19, s[24:27], s60 offen offset:1024 nt
    ds_write_b128 v1, v[44:47] offset:2048
    ds_write_b128 v1, v[48:51] offset:3072
    buffer_load_dwordx4 v[220:223], v20, s[24:27], s60 offen offset:2048 nt
    buffer_load_dwordx4 v[224:227], v21, s[24:27], s60 offen offset:3072 nt
    s_waitcnt vmcnt(4)
    s_waitcnt lgkmcnt(0)
    s_barrier
    s_mov_b32 s60, 36864
    buffer_load_dwordx4 v[228:231], v22, s[28:31], s60 offen offset:0 nt
    ds_write_b128 v1, v[52:55] offset:16384
    ds_write_b128 v1, v[56:59] offset:17408
    buffer_load_dwordx4 v[232:235], v23, s[28:31], s60 offen offset:1024 nt
    ds_write_b128 v1, v[60:63] offset:18432
    ds_write_b128 v1, v[64:67] offset:19456
    buffer_load_dwordx4 v[236:239], v34, s[28:31], s60 offen offset:2048 nt
    ds_write_b128 v2, v[68:71] offset:0
    ds_write_b128 v2, v[72:75] offset:1024
    buffer_load_dwordx4 v[240:243], v35, s[28:31], s60 offen offset:3072 nt
    ds_write_b128 v2, v[76:79] offset:2048
    ds_write_b128 v2, v[80:83] offset:3072
    s_waitcnt lgkmcnt(0)
    s_barrier
    s_mov_b32 s60, 37888
    s_waitcnt vmcnt(7)
    buffer_load_dwordx4 v[244:247], v18, s[24:27], s60 offen offset:0 nt
    ds_write_b128 v1, v[84:87] offset:32768
    ds_write_b128 v1, v[88:91] offset:33792
    s_waitcnt vmcnt(7)
    buffer_load_dwordx4 v[248:251], v19, s[24:27], s60 offen offset:1024 nt
    ds_write_b128 v1, v[92:95] offset:34816
    ds_write_b128 v1, v[96:99] offset:35840
    s_waitcnt vmcnt(7)
    buffer_load_dwordx4 v[252:255], v20, s[24:27], s60 offen offset:2048 nt
    ds_write_b128 v2, v[100:103] offset:16384
    ds_write_b128 v2, v[104:107] offset:17408
    s_waitcnt vmcnt(7)
    buffer_load_dwordx4 v[36:39], v21, s[24:27], s60 offen offset:3072 nt
    ds_write_b128 v2, v[108:111] offset:18432
    ds_write_b128 v2, v[112:115] offset:19456
    s_mov_b32 s60, 33792
    s_waitcnt vmcnt(7)
    buffer_load_dwordx4 v[40:43], v22, s[28:31], s60 offen offset:0 nt
    s_waitcnt vmcnt(7)
    buffer_load_dwordx4 v[44:47], v23, s[28:31], s60 offen offset:1024 nt
    s_waitcnt vmcnt(7)
    buffer_load_dwordx4 v[48:51], v34, s[28:31], s60 offen offset:2048 nt
    s_waitcnt vmcnt(7)
    buffer_load_dwordx4 v[52:55], v35, s[28:31], s60 offen offset:3072 nt
    s_waitcnt lgkmcnt(0)
    s_barrier
    s_mov_b32 s60, 65536
    s_waitcnt vmcnt(4)
    buffer_load_dwordx4 v[56:59], v18, s[24:27], s60 offen offset:0 nt
    ds_write_b128 v1, v[116:119] offset:0
    ds_write_b128 v1, v[120:123] offset:1024
    s_waitcnt vmcnt(4)
    buffer_load_dwordx4 v[60:63], v19, s[24:27], s60 offen offset:1024 nt
    ds_write_b128 v1, v[124:127] offset:2048
    ds_write_b128 v1, v[128:131] offset:3072
    s_waitcnt vmcnt(4)
    buffer_load_dwordx4 v[64:67], v20, s[24:27], s60 offen offset:2048 nt
    ds_write_b128 v2, v[132:135] offset:32768
    ds_write_b128 v2, v[136:139] offset:33792
    s_waitcnt vmcnt(4)
    buffer_load_dwordx4 v[68:71], v21, s[24:27], s60 offen offset:3072 nt
    ds_write_b128 v2, v[140:143] offset:34816
    ds_write_b128 v2, v[144:147] offset:35840
    s_mov_b32 s60, 37888
    s_waitcnt vmcnt(4)
    buffer_load_dwordx4 v[72:75], v22, s[28:31], s60 offen offset:0 nt
    s_waitcnt lgkmcnt(0)
    s_barrier
    s_mov_b32 s60, 37888
    s_waitcnt vmcnt(4)
    buffer_load_dwordx4 v[76:79], v23, s[28:31], s60 offen offset:1024 nt
    ds_write_b128 v1, v[148:151] offset:16384
    ds_write_b128 v1, v[152:155] offset:17408
    s_waitcnt vmcnt(4)
    buffer_load_dwordx4 v[80:83], v34, s[28:31], s60 offen offset:2048 nt
    ds_write_b128 v1, v[156:159] offset:18432
    ds_write_b128 v1, v[160:163] offset:19456
    s_waitcnt vmcnt(4)
    buffer_load_dwordx4 v[84:87], v35, s[28:31], s60 offen offset:3072 nt
    ds_write_b128 v2, v[164:167] offset:0
    ds_write_b128 v2, v[168:171] offset:1024
    s_mov_b32 s60, 69632
    s_waitcnt vmcnt(4)
    buffer_load_dwordx4 v[88:91], v18, s[24:27], s60 offen offset:0 nt
    ds_write_b128 v2, v[172:175] offset:2048
    ds_write_b128 v2, v[176:179] offset:3072
    s_waitcnt vmcnt(4)
    buffer_load_dwordx4 v[92:95], v19, s[24:27], s60 offen offset:1024 nt
    s_waitcnt lgkmcnt(0)
    s_barrier
    s_mov_b32 s60, 69632
    s_waitcnt vmcnt(4)
    buffer_load_dwordx4 v[96:99], v20, s[24:27], s60 offen offset:2048 nt
    ds_write_b128 v1, v[180:183] offset:32768
    ds_write_b128 v1, v[184:187] offset:33792
    s_waitcnt vmcnt(4)
    buffer_load_dwordx4 v[100:103], v21, s[24:27], s60 offen offset:3072 nt
    ds_write_b128 v1, v[188:191] offset:34816
    ds_write_b128 v1, v[192:195] offset:35840
    s_mov_b32 s60, 65536
    s_waitcnt vmcnt(4)
    buffer_load_dwordx4 v[104:107], v22, s[28:31], s60 offen offset:0 nt
    ds_write_b128 v2, v[196:199] offset:16384
    ds_write_b128 v2, v[200:203] offset:17408
    s_waitcnt vmcnt(4)
    buffer_load_dwordx4 v[108:111], v23, s[28:31], s60 offen offset:1024 nt
    ds_write_b128 v2, v[204:207] offset:18432
    ds_write_b128 v2, v[208:211] offset:19456
    s_waitcnt vmcnt(4)
    buffer_load_dwordx4 v[112:115], v34, s[28:31], s60 offen offset:2048 nt
    s_waitcnt lgkmcnt(0)
    s_barrier
    s_mov_b32 s60, 65536
    s_waitcnt vmcnt(4)
    buffer_load_dwordx4 v[116:119], v35, s[28:31], s60 offen offset:3072 nt
    ds_write_b128 v1, v[212:215] offset:0
    ds_write_b128 v1, v[216:219] offset:1024
    s_mov_b32 s60, 66560
    s_waitcnt vmcnt(4)
    buffer_load_dwordx4 v[120:123], v18, s[24:27], s60 offen offset:0 nt
    ds_write_b128 v1, v[220:223] offset:2048
    ds_write_b128 v1, v[224:227] offset:3072
    s_waitcnt vmcnt(4)
    buffer_load_dwordx4 v[124:127], v19, s[24:27], s60 offen offset:1024 nt
    ds_write_b128 v2, v[228:231] offset:32768
    ds_write_b128 v2, v[232:235] offset:33792
    s_waitcnt vmcnt(4)
    buffer_load_dwordx4 v[128:131], v20, s[24:27], s60 offen offset:2048 nt
    ds_write_b128 v2, v[236:239] offset:34816
    ds_write_b128 v2, v[240:243] offset:35840
    s_waitcnt vmcnt(4)
    buffer_load_dwordx4 v[132:135], v21, s[24:27], s60 offen offset:3072 nt
    s_waitcnt lgkmcnt(0)
    s_barrier
    s_mov_b32 s60, 69632
    s_waitcnt vmcnt(4)
    buffer_load_dwordx4 v[136:139], v22, s[28:31], s60 offen offset:0 nt
    ds_write_b128 v1, v[244:247] offset:16384
    ds_write_b128 v1, v[248:251] offset:17408
    s_waitcnt vmcnt(4)
    buffer_load_dwordx4 v[140:143], v23, s[28:31], s60 offen offset:1024 nt
    ds_write_b128 v1, v[252:255] offset:18432
    ds_write_b128 v1, v[36:39] offset:19456
    s_waitcnt vmcnt(4)
    buffer_load_dwordx4 v[144:147], v34, s[28:31], s60 offen offset:2048 nt
    ds_write_b128 v2, v[40:43] offset:0
    ds_write_b128 v2, v[44:47] offset:1024
    s_waitcnt vmcnt(4)
    buffer_load_dwordx4 v[148:151], v35, s[28:31], s60 offen offset:3072 nt
    ds_write_b128 v2, v[48:51] offset:2048
    ds_write_b128 v2, v[52:55] offset:3072
    s_mov_b32 s60, 70656
    s_waitcnt vmcnt(4)
    buffer_load_dwordx4 v[152:155], v18, s[24:27], s60 offen offset:0 nt
    s_waitcnt vmcnt(4)
    buffer_load_dwordx4 v[156:159], v19, s[24:27], s60 offen offset:1024 nt
    s_waitcnt lgkmcnt(0)
    s_barrier
    s_mov_b32 s60, 70656
    s_waitcnt vmcnt(4)
    buffer_load_dwordx4 v[160:163], v20, s[24:27], s60 offen offset:2048 nt
    ds_write_b128 v1, v[56:59] offset:32768
    ds_write_b128 v1, v[60:63] offset:33792
    s_waitcnt vmcnt(4)
    buffer_load_dwordx4 v[164:167], v21, s[24:27], s60 offen offset:3072 nt
    ds_write_b128 v1, v[64:67] offset:34816
    ds_write_b128 v1, v[68:71] offset:35840
    s_mov_b32 s60, 66560
    s_waitcnt vmcnt(4)
    buffer_load_dwordx4 v[168:171], v22, s[28:31], s60 offen offset:0 nt
    ds_write_b128 v2, v[72:75] offset:16384
    ds_write_b128 v2, v[76:79] offset:17408
    s_waitcnt vmcnt(4)
    buffer_load_dwordx4 v[172:175], v23, s[28:31], s60 offen offset:1024 nt
    ds_write_b128 v2, v[80:83] offset:18432
    ds_write_b128 v2, v[84:87] offset:19456
    s_waitcnt vmcnt(4)
    buffer_load_dwordx4 v[176:179], v34, s[28:31], s60 offen offset:2048 nt
    s_waitcnt lgkmcnt(0)
    s_barrier
    s_mov_b32 s60, 66560
    s_waitcnt vmcnt(4)
    buffer_load_dwordx4 v[180:183], v35, s[28:31], s60 offen offset:3072 nt
    ds_write_b128 v1, v[88:91] offset:0
    ds_write_b128 v1, v[92:95] offset:1024
    s_mov_b32 s60, 98304
    s_waitcnt vmcnt(4)
    buffer_load_dwordx4 v[184:187], v18, s[24:27], s60 offen offset:0 nt
    ds_write_b128 v1, v[96:99] offset:2048
    ds_write_b128 v1, v[100:103] offset:3072
    s_waitcnt vmcnt(4)
    buffer_load_dwordx4 v[188:191], v19, s[24:27], s60 offen offset:1024 nt
    ds_write_b128 v2, v[104:107] offset:32768
    ds_write_b128 v2, v[108:111] offset:33792
    s_waitcnt vmcnt(4)
    buffer_load_dwordx4 v[192:195], v20, s[24:27], s60 offen offset:2048 nt
    ds_write_b128 v2, v[112:115] offset:34816
    ds_write_b128 v2, v[116:119] offset:35840
    s_waitcnt vmcnt(4)
    buffer_load_dwordx4 v[196:199], v21, s[24:27], s60 offen offset:3072 nt
    s_waitcnt lgkmcnt(0)
    s_barrier
    s_mov_b32 s60, 70656
    s_waitcnt vmcnt(4)
    buffer_load_dwordx4 v[200:203], v22, s[28:31], s60 offen offset:0 nt
    ds_write_b128 v1, v[120:123] offset:16384
    ds_write_b128 v1, v[124:127] offset:17408
    s_waitcnt vmcnt(4)
    buffer_load_dwordx4 v[204:207], v23, s[28:31], s60 offen offset:1024 nt
    ds_write_b128 v1, v[128:131] offset:18432
    ds_write_b128 v1, v[132:135] offset:19456
    s_waitcnt vmcnt(4)
    buffer_load_dwordx4 v[208:211], v34, s[28:31], s60 offen offset:2048 nt
    ds_write_b128 v2, v[136:139] offset:0
    ds_write_b128 v2, v[140:143] offset:1024
    s_waitcnt vmcnt(4)
    buffer_load_dwordx4 v[212:215], v35, s[28:31], s60 offen offset:3072 nt
    ds_write_b128 v2, v[144:147] offset:2048
    ds_write_b128 v2, v[148:151] offset:3072
    s_mov_b32 s60, 102400
    s_waitcnt vmcnt(4)
    buffer_load_dwordx4 v[216:219], v18, s[24:27], s60 offen offset:0 nt
    s_waitcnt lgkmcnt(0)
    s_barrier
    s_mov_b32 s60, 102400
    s_waitcnt vmcnt(4)
    buffer_load_dwordx4 v[220:223], v19, s[24:27], s60 offen offset:1024 nt
    ds_write_b128 v1, v[152:155] offset:32768
    ds_write_b128 v1, v[156:159] offset:33792
    s_waitcnt vmcnt(4)
    buffer_load_dwordx4 v[224:227], v20, s[24:27], s60 offen offset:2048 nt
    ds_write_b128 v1, v[160:163] offset:34816
    ds_write_b128 v1, v[164:167] offset:35840
    s_waitcnt vmcnt(4)
    buffer_load_dwordx4 v[228:231], v21, s[24:27], s60 offen offset:3072 nt
    ds_write_b128 v2, v[168:171] offset:16384
    ds_write_b128 v2, v[172:175] offset:17408
    s_mov_b32 s60, 98304
    s_waitcnt vmcnt(4)
    buffer_load_dwordx4 v[232:235], v22, s[28:31], s60 offen offset:0 nt
    ds_write_b128 v2, v[176:179] offset:18432
    ds_write_b128 v2, v[180:183] offset:19456
    s_waitcnt vmcnt(4)
    buffer_load_dwordx4 v[236:239], v23, s[28:31], s60 offen offset:1024 nt
    s_waitcnt vmcnt(4)
    buffer_load_dwordx4 v[240:243], v34, s[28:31], s60 offen offset:2048 nt
    s_waitcnt lgkmcnt(0)
    s_barrier
    s_mov_b32 s60, 98304
    s_waitcnt vmcnt(4)
    buffer_load_dwordx4 v[244:247], v35, s[28:31], s60 offen offset:3072 nt
    ds_write_b128 v1, v[184:187] offset:0
    ds_write_b128 v1, v[188:191] offset:1024
    s_mov_b32 s60, 99328
    s_waitcnt vmcnt(4)
    buffer_load_dwordx4 v[248:251], v18, s[24:27], s60 offen offset:0 nt
    ds_write_b128 v1, v[192:195] offset:2048
    ds_write_b128 v1, v[196:199] offset:3072
    s_waitcnt vmcnt(4)
    buffer_load_dwordx4 v[252:255], v19, s[24:27], s60 offen offset:1024 nt
    ds_write_b128 v2, v[200:203] offset:32768
    ds_write_b128 v2, v[204:207] offset:33792
    s_waitcnt vmcnt(4)
    buffer_load_dwordx4 v[36:39], v20, s[24:27], s60 offen offset:2048 nt
    ds_write_b128 v2, v[208:211] offset:34816
    ds_write_b128 v2, v[212:215] offset:35840
    s_waitcnt vmcnt(4)
    buffer_load_dwordx4 v[40:43], v21, s[24:27], s60 offen offset:3072 nt
    buffer_load_dword v31, v29, s[44:47], 0 offen sc1
    s_waitcnt lgkmcnt(0)
    s_barrier
    s_mov_b32 s60, 102400
    s_waitcnt vmcnt(4)
    buffer_load_dwordx4 v[44:47], v22, s[28:31], s60 offen offset:0 nt
    ds_write_b128 v1, v[216:219] offset:16384
    ds_write_b128 v1, v[220:223] offset:17408
    s_waitcnt vmcnt(4)
    buffer_load_dwordx4 v[48:51], v23, s[28:31], s60 offen offset:1024 nt
    ds_write_b128 v1, v[224:227] offset:18432
    ds_write_b128 v1, v[228:231] offset:19456
    s_waitcnt vmcnt(4)
    buffer_load_dwordx4 v[52:55], v34, s[28:31], s60 offen offset:2048 nt
    ds_write_b128 v2, v[232:235] offset:0
    ds_write_b128 v2, v[236:239] offset:1024
    s_waitcnt vmcnt(4)
    buffer_load_dwordx4 v[56:59], v35, s[28:31], s60 offen offset:3072 nt
    ds_write_b128 v2, v[240:243] offset:2048
    ds_write_b128 v2, v[244:247] offset:3072
    s_mov_b32 s60, 103424
    s_waitcnt vmcnt(4)
    buffer_load_dwordx4 v[60:63], v18, s[24:27], s60 offen offset:0 nt
    s_waitcnt lgkmcnt(0)
    s_barrier
    s_mov_b32 s60, 103424
    s_waitcnt vmcnt(4)
    buffer_load_dwordx4 v[64:67], v19, s[24:27], s60 offen offset:1024 nt
    ds_write_b128 v1, v[248:251] offset:32768
    ds_write_b128 v1, v[252:255] offset:33792
    s_waitcnt vmcnt(4)
    buffer_load_dwordx4 v[68:71], v20, s[24:27], s60 offen offset:2048 nt
    ds_write_b128 v1, v[36:39] offset:34816
    ds_write_b128 v1, v[40:43] offset:35840
    s_waitcnt vmcnt(4)
    buffer_load_dwordx4 v[72:75], v21, s[24:27], s60 offen offset:3072 nt
    ds_write_b128 v2, v[44:47] offset:16384
    ds_write_b128 v2, v[48:51] offset:17408
    s_mov_b32 s60, 99328
    s_waitcnt vmcnt(4)
    buffer_load_dwordx4 v[76:79], v22, s[28:31], s60 offen offset:0 nt
    ds_write_b128 v2, v[52:55] offset:18432
    ds_write_b128 v2, v[56:59] offset:19456
    s_waitcnt vmcnt(4)
    buffer_load_dwordx4 v[80:83], v23, s[28:31], s60 offen offset:1024 nt
    s_waitcnt lgkmcnt(0)
    s_barrier
    s_add_u32 m0, s70, 147456
    s_mov_b32 s60, 99328
    s_waitcnt vmcnt(4)
    buffer_load_dwordx4 v34, s[28:31], s60 offen offset:2048 nt lds
    ds_write_b128 v1, v[60:63] offset:0
    ds_write_b128 v1, v[64:67] offset:1024
    s_waitcnt vmcnt(4)
    buffer_load_dwordx4 v35, s[28:31], s60 offen offset:3072 nt lds
    ds_write_b128 v1, v[68:71] offset:2048
    s_mov_b32 s60, 103424
    s_waitcnt vmcnt(4)
    buffer_load_dwordx4 v[84:87], v22, s[28:31], s60 offen offset:0 nt
    ds_write_b128 v1, v[72:75] offset:3072
    s_waitcnt vmcnt(4)
    buffer_load_dwordx4 v[88:91], v23, s[28:31], s60 offen offset:1024 nt
    ds_write_b128 v2, v[76:79] offset:32768
    s_waitcnt vmcnt(4)
    buffer_load_dwordx4 v[92:95], v34, s[28:31], s60 offen offset:2048 nt
    ds_write_b128 v2, v[80:83] offset:33792
    s_waitcnt vmcnt(4)
    buffer_load_dwordx4 v[96:99], v35, s[28:31], s60 offen offset:3072 nt
    s_waitcnt lgkmcnt(0)
    s_barrier
    s_waitcnt vmcnt(4)
    s_barrier
    s_waitcnt vmcnt(3)
    ds_write_b128 v2, v[84:87] offset:0
    s_waitcnt vmcnt(2)
    ds_write_b128 v2, v[88:91] offset:1024
    s_waitcnt vmcnt(1)
    ds_write_b128 v2, v[92:95] offset:2048
    s_waitcnt vmcnt(0)
    ds_write_b128 v2, v[96:99] offset:3072
    s_add_u32 s60, s72, 0
    s_add_u32 m0, s70, 0
    s_and_b32 s60, s60, 15
    s_lshl_b32 s61, s60, 17
    s_lshr_b32 s60, s60, 1
    s_lshr_b32 s62, s60, 1
    s_xor_b32 s62, s62, s53
    s_lshl_b32 s62, s62, 3
    s_add_u32 s62, s62, s60
    s_lshl_b32 s62, s62, 18
    s_and_b32 s61, s61, 0x20000
    s_add_u32 s61, s61, s62
    buffer_load_dwordx4 v24, s[36:39], s61 offen offset:0  lds
    buffer_load_dwordx4 v25, s[36:39], s61 offen offset:1024  lds
    buffer_load_dwordx4 v26, s[36:39], s61 offen offset:2048  lds
    buffer_load_dwordx4 v27, s[36:39], s61 offen offset:3072  lds
    s_add_u32 s60, s72, 1
    s_add_u32 m0, s70, 16384
    s_and_b32 s60, s60, 15
    s_lshl_b32 s61, s60, 17
    s_lshr_b32 s60, s60, 1
    s_lshr_b32 s62, s60, 1
    s_xor_b32 s62, s62, s53
    s_lshl_b32 s62, s62, 3
    s_add_u32 s62, s62, s60
    s_lshl_b32 s62, s62, 18
    s_and_b32 s61, s61, 0x20000
    s_add_u32 s61, s61, s62
    buffer_load_dwordx4 v24, s[36:39], s61 offen offset:0  lds
    buffer_load_dwordx4 v25, s[36:39], s61 offen offset:1024  lds
    buffer_load_dwordx4 v26, s[36:39], s61 offen offset:2048  lds
    buffer_load_dwordx4 v27, s[36:39], s61 offen offset:3072  lds
    s_waitcnt lgkmcnt(0)
    s_barrier
    s_waitcnt vmcnt(0)
    s_barrier
    s_add_u32 s60, s72, 4
    s_add_u32 m0, s70, 32768
    s_and_b32 s60, s60, 15
    s_lshl_b32 s61, s60, 17
    s_lshr_b32 s60, s60, 1
    s_lshr_b32 s62, s60, 1
    s_xor_b32 s62, s62, s53
    s_lshl_b32 s62, s62, 3
    s_add_u32 s62, s62, s60
    s_lshl_b32 s62, s62, 18
    s_and_b32 s61, s61, 0x20000
    s_add_u32 s61, s61, s62
    buffer_load_dwordx4 v24, s[36:39], s61 offen offset:0  lds
    buffer_load_dwordx4 v25, s[36:39], s61 offen offset:1024  lds
    buffer_load_dwordx4 v26, s[36:39], s61 offen offset:2048  lds
    buffer_load_dwordx4 v27, s[36:39], s61 offen offset:3072  lds
    s_add_u32 s60, s72, 8
    s_add_u32 m0, s70, 49152
    s_and_b32 s60, s60, 15
    s_lshl_b32 s61, s60, 17
    s_lshr_b32 s60, s60, 1
    s_lshr_b32 s62, s60, 1
    s_xor_b32 s62, s62, s53
    s_lshl_b32 s62, s62, 3
    s_add_u32 s62, s62, s60
    s_lshl_b32 s62, s62, 18
    s_and_b32 s61, s61, 0x20000
    s_add_u32 s61, s61, s62
    buffer_load_dwordx4 v24, s[36:39], s61 offen offset:0  lds
    buffer_load_dwordx4 v25, s[36:39], s61 offen offset:1024  lds
    buffer_load_dwordx4 v26, s[36:39], s61 offen offset:2048  lds
    buffer_load_dwordx4 v27, s[36:39], s61 offen offset:3072  lds
    s_mov_b32 s77, 0
    s_add_u32 s60, s72, 4
    s_bfe_u32 s61, s60, 0x30001
    s_mov_b32 s73, 0
L_need2a:
    s_bitcmp1_b32 s77, s61
    s_cbranch_scc1 L_need2a_done
    buffer_load_dword v31, v29, s[44:47], 0 offen sc1
    s_add_u32 s73, s73, 1
    s_waitcnt vmcnt(0)
    v_cmp_eq_u32 vcc, 1, v31
    s_mov_b32 s77, vcc_lo
    s_cmp_lt_u32 s73, 400000
    s_cbranch_scc1 L_need2a
L_need2a_done:
    s_add_u32 s60, s72, 8
    s_bfe_u32 s61, s60, 0x30001
    s_mov_b32 s73, 0
L_need3a:
    s_bitcmp1_b32 s77, s61
    s_cbranch_scc1 L_need3a_done
    buffer_load_dword v31, v29, s[44:47], 0 offen sc1
    s_add_u32 s73, s73, 1
    s_waitcnt vmcnt(0)
    v_cmp_eq_u32 vcc, 1, v31
    s_mov_b32 s77, vcc_lo
    s_cmp_lt_u32 s73, 400000
    s_cbranch_scc1 L_need3a
L_need3a_done:
    s_barrier
    s_add_u32 s60, s72, 12
    s_bfe_u32 s61, s60, 0x30001
    s_mov_b32 s73, 0
L_need4a:
    s_bitcmp1_b32 s77, s61
    s_cbranch_scc1 L_need4a_done
    buffer_load_dword v31, v29, s[44:47], 0 offen sc1
    s_add_u32 s73, s73, 1
    s_waitcnt vmcnt(0)
    v_cmp_eq_u32 vcc, 1, v31
    s_mov_b32 s77, vcc_lo
    s_cmp_lt_u32 s73, 400000
    s_cbranch_scc1 L_need4a
L_need4a_done:
    s_waitcnt vmcnt(4)
    s_barrier
    s_add_u32 s60, s72, 12
    s_add_u32 m0, s70, 0
    s_and_b32 s60, s60, 15
    s_lshl_b32 s61, s60, 17
    s_lshr_b32 s60, s60, 1
    s_lshr_b32 s62, s60, 1
    s_xor_b32 s62, s62, s53
    s_lshl_b32 s62, s62, 3
    s_add_u32 s62, s62, s60
    s_lshl_b32 s62, s62, 18
    s_and_b32 s61, s61, 0x20000
    s_add_u32 s61, s61, s62
    buffer_load_dwordx4 v24, s[36:39], s61 offen offset:0  lds
    buffer_load_dwordx4 v25, s[36:39], s61 offen offset:1024  lds
    buffer_load_dwordx4 v26, s[36:39], s61 offen offset:2048  lds
    buffer_load_dwordx4 v27, s[36:39], s61 offen offset:3072  lds
    s_add_u32 s60, s72, 5
    s_add_u32 m0, s70, 16384
    s_and_b32 s60, s60, 15
    s_lshl_b32 s61, s60, 17
    s_lshr_b32 s60, s60, 1
    s_lshr_b32 s62, s60, 1
    s_xor_b32 s62, s62, s53
    s_lshl_b32 s62, s62, 3
    s_add_u32 s62, s62, s60
    s_lshl_b32 s62, s62, 18
    s_and_b32 s61, s61, 0x20000
    s_add_u32 s61, s61, s62
    buffer_load_dwordx4 v24, s[36:39], s61 offen offset:0  lds
    buffer_load_dwordx4 v25, s[36:39], s61 offen offset:1024  lds
    buffer_load_dwordx4 v26, s[36:39], s61 offen offset:2048  lds
    buffer_load_dwordx4 v27, s[36:39], s61 offen offset:3072  lds
    s_waitcnt vmcnt(8)
    s_barrier
    s_add_u32 s60, s72, 9
    s_add_u32 m0, s70, 32768
    s_and_b32 s60, s60, 15
    s_lshl_b32 s61, s60, 17
    s_lshr_b32 s60, s60, 1
    s_lshr_b32 s62, s60, 1
    s_xor_b32 s62, s62, s53
    s_lshl_b32 s62, s62, 3
    s_add_u32 s62, s62, s60
    s_lshl_b32 s62, s62, 18
    s_and_b32 s61, s61, 0x20000
    s_add_u32 s61, s61, s62
    buffer_load_dwordx4 v24, s[36:39], s61 offen offset:0  lds
    buffer_load_dwordx4 v25, s[36:39], s61 offen offset:1024  lds
    buffer_load_dwordx4 v26, s[36:39], s61 offen offset:2048  lds
    buffer_load_dwordx4 v27, s[36:39], s61 offen offset:3072  lds
    s_waitcnt vmcnt(8)
    s_barrier
    s_add_u32 s60, s72, 13
    s_add_u32 m0, s70, 49152
    s_and_b32 s60, s60, 15
    s_lshl_b32 s61, s60, 17
    s_lshr_b32 s60, s60, 1
    s_lshr_b32 s62, s60, 1
    s_xor_b32 s62, s62, s53
    s_lshl_b32 s62, s62, 3
    s_add_u32 s62, s62, s60
    s_lshl_b32 s62, s62, 18
    s_and_b32 s61, s61, 0x20000
    s_add_u32 s61, s61, s62
    buffer_load_dwordx4 v24, s[36:39], s61 offen offset:0  lds
    buffer_load_dwordx4 v25, s[36:39], s61 offen offset:1024  lds
    buffer_load_dwordx4 v26, s[36:39], s61 offen offset:2048  lds
    buffer_load_dwordx4 v27, s[36:39], s61 offen offset:3072  lds
    s_waitcnt vmcnt(8)
    s_barrier
    s_add_u32 s60, s72, 2
    s_add_u32 m0, s70, 0
    s_and_b32 s60, s60, 15
    s_lshl_b32 s61, s60, 17
    s_lshr_b32 s60, s60, 1
    s_lshr_b32 s62, s60, 1
    s_xor_b32 s62, s62, s53
    s_lshl_b32 s62, s62, 3
    s_add_u32 s62, s62, s60
    s_lshl_b32 s62, s62, 18
    s_and_b32 s61, s61, 0x20000
    s_add_u32 s61, s61, s62
    buffer_load_dwordx4 v24, s[36:39], s61 offen offset:0  lds
    buffer_load_dwordx4 v25, s[36:39], s61 offen offset:1024  lds
    buffer_load_dwordx4 v26, s[36:39], s61 offen offset:2048  lds
    buffer_load_dwordx4 v27, s[36:39], s61 offen offset:3072  lds
    s_add_u32 s60, s72, 2
    s_bfe_u32 s61, s60, 0x30001
    s_mov_b32 s73, 0
L_need8a:
    s_bitcmp1_b32 s77, s61
    s_cbranch_scc1 L_need8a_done
    buffer_load_dword v31, v29, s[44:47], 0 offen sc1
    s_add_u32 s73, s73, 1
    s_waitcnt vmcnt(0)
    v_cmp_eq_u32 vcc, 1, v31
    s_mov_b32 s77, vcc_lo
    s_cmp_lt_u32 s73, 400000
    s_cbranch_scc1 L_need8a
L_need8a_done:
    s_waitcnt vmcnt(8)
    s_barrier
    s_add_u32 s60, s72, 6
    s_add_u32 m0, s70, 16384
    s_and_b32 s60, s60, 15
    s_lshl_b32 s61, s60, 17
    s_lshr_b32 s60, s60, 1
    s_lshr_b32 s62, s60, 1
    s_xor_b32 s62, s62, s53
    s_lshl_b32 s62, s62, 3
    s_add_u32 s62, s62, s60
    s_lshl_b32 s62, s62, 18
    s_and_b32 s61, s61, 0x20000
    s_add_u32 s61, s61, s62
    buffer_load_dwordx4 v24, s[36:39], s61 offen offset:0  lds
    buffer_load_dwordx4 v25, s[36:39], s61 offen offset:1024  lds
    buffer_load_dwordx4 v26, s[36:39], s61 offen offset:2048  lds
    buffer_load_dwordx4 v27, s[36:39], s61 offen offset:3072  lds
    s_add_u32 s60, s72, 6
    s_bfe_u32 s61, s60, 0x30001
    s_mov_b32 s73, 0
L_need9a:
    s_bitcmp1_b32 s77, s61
    s_cbranch_scc1 L_need9a_done
    buffer_load_dword v31, v29, s[44:47], 0 offen sc1
    s_add_u32 s73, s73, 1
    s_waitcnt vmcnt(0)
    v_cmp_eq_u32 vcc, 1, v31
    s_mov_b32 s77, vcc_lo
    s_cmp_lt_u32 s73, 400000
    s_cbranch_scc1 L_need9a
L_need9a_done:
    s_waitcnt vmcnt(8)
    s_barrier
    s_add_u32 s60, s72, 10
    s_add_u32 m0, s70, 32768
    s_and_b32 s60, s60, 15
    s_lshl_b32 s61, s60, 17
    s_lshr_b32 s60, s60, 1
    s_lshr_b32 s62, s60, 1
    s_xor_b32 s62, s62, s53
    s_lshl_b32 s62, s62, 3
    s_add_u32 s62, s62, s60
    s_lshl_b32 s62, s62, 18
    s_and_b32 s61, s61, 0x20000
    s_add_u32 s61, s61, s62
    buffer_load_dwordx4 v24, s[36:39], s61 offen offset:0  lds
    buffer_load_dwordx4 v25, s[36:39], s61 offen offset:1024  lds
    buffer_load_dwordx4 v26, s[36:39], s61 offen offset:2048  lds
    buffer_load_dwordx4 v27, s[36:39], s61 offen offset:3072  lds
    s_add_u32 s60, s72, 10
    s_bfe_u32 s61, s60, 0x30001
    s_mov_b32 s73, 0
L_need10a:
    s_bitcmp1_b32 s77, s61
    s_cbranch_scc1 L_need10a_done
    buffer_load_dword v31, v29, s[44:47], 0 offen sc1
    s_add_u32 s73, s73, 1
    s_waitcnt vmcnt(0)
    v_cmp_eq_u32 vcc, 1, v31
    s_mov_b32 s77, vcc_lo
    s_cmp_lt_u32 s73, 400000
    s_cbranch_scc1 L_need10a
L_need10a_done:
    s_waitcnt vmcnt(8)
    s_barrier
    s_add_u32 s60, s72, 14
    s_add_u32 m0, s70, 49152
    s_and_b32 s60, s60, 15
    s_lshl_b32 s61, s60, 17
    s_lshr_b32 s60, s60, 1
    s_lshr_b32 s62, s60, 1
    s_xor_b32 s62, s62, s53
    s_lshl_b32 s62, s62, 3
    s_add_u32 s62, s62, s60
    s_lshl_b32 s62, s62, 18
    s_and_b32 s61, s61, 0x20000
    s_add_u32 s61, s61, s62
    buffer_load_dwordx4 v24, s[36:39], s61 offen offset:0  lds
    buffer_load_dwordx4 v25, s[36:39], s61 offen offset:1024  lds
    buffer_load_dwordx4 v26, s[36:39], s61 offen offset:2048  lds
    buffer_load_dwordx4 v27, s[36:39], s61 offen offset:3072  lds
    s_add_u32 s60, s72, 14
    s_bfe_u32 s61, s60, 0x30001
    s_mov_b32 s73, 0
L_need11a:
    s_bitcmp1_b32 s77, s61
    s_cbranch_scc1 L_need11a_done
    buffer_load_dword v31, v29, s[44:47], 0 offen sc1
    s_add_u32 s73, s73, 1
    s_waitcnt vmcnt(0)
    v_cmp_eq_u32 vcc, 1, v31
    s_mov_b32 s77, vcc_lo
    s_cmp_lt_u32 s73, 400000
    s_cbranch_scc1 L_need11a
L_need11a_done:
    s_waitcnt vmcnt(8)
    s_barrier
    s_add_u32 s60, s72, 3
    s_add_u32 m0, s70, 0
    s_and_b32 s60, s60, 15
    s_lshl_b32 s61, s60, 17
    s_lshr_b32 s60, s60, 1
    s_lshr_b32 s62, s60, 1
    s_xor_b32 s62, s62, s53
    s_lshl_b32 s62, s62, 3
    s_add_u32 s62, s62, s60
    s_lshl_b32 s62, s62, 18
    s_and_b32 s61, s61, 0x20000
    s_add_u32 s61, s61, s62
    buffer_load_dwordx4 v24, s[36:39], s61 offen offset:0  lds
    buffer_load_dwordx4 v25, s[36:39], s61 offen offset:1024  lds
    buffer_load_dwordx4 v26, s[36:39], s61 offen offset:2048  lds
    buffer_load_dwordx4 v27, s[36:39], s61 offen offset:3072  lds
    s_waitcnt vmcnt(8)
    s_barrier
    s_add_u32 s60, s72, 7
    s_add_u32 m0, s70, 16384
    s_and_b32 s60, s60, 15
    s_lshl_b32 s61, s60, 17
    s_lshr_b32 s60, s60, 1
    s_lshr_b32 s62, s60, 1
    s_xor_b32 s62, s62, s53
    s_lshl_b32 s62, s62, 3
    s_add_u32 s62, s62, s60
    s_lshl_b32 s62, s62, 18
    s_and_b32 s61, s61, 0x20000
    s_add_u32 s61, s61, s62
    buffer_load_dwordx4 v24, s[36:39], s61 offen offset:0  lds
    buffer_load_dwordx4 v25, s[36:39], s61 offen offset:1024  lds
    buffer_load_dwordx4 v26, s[36:39], s61 offen offset:2048  lds
    buffer_load_dwordx4 v27, s[36:39], s61 offen offset:3072  lds
    s_waitcnt vmcnt(8)
    s_barrier
    s_add_u32 s60, s72, 11
    s_add_u32 m0, s70, 32768
    s_and_b32 s60, s60, 15
    s_lshl_b32 s61, s60, 17
    s_lshr_b32 s60, s60, 1
    s_lshr_b32 s62, s60, 1
    s_xor_b32 s62, s62, s53
    s_lshl_b32 s62, s62, 3
    s_add_u32 s62, s62, s60
    s_lshl_b32 s62, s62, 18
    s_and_b32 s61, s61, 0x20000
    s_add_u32 s61, s61, s62
    buffer_load_dwordx4 v24, s[36:39], s61 offen offset:0  lds
    buffer_load_dwordx4 v25, s[36:39], s61 offen offset:1024  lds
    buffer_load_dwordx4 v26, s[36:39], s61 offen offset:2048  lds
    buffer_load_dwordx4 v27, s[36:39], s61 offen offset:3072  lds
    s_waitcnt vmcnt(8)
    s_barrier
    s_add_u32 s60, s72, 15
    s_add_u32 m0, s70, 49152
    s_and_b32 s60, s60, 15
    s_lshl_b32 s61, s60, 17
    s_lshr_b32 s60, s60, 1
    s_lshr_b32 s62, s60, 1
    s_xor_b32 s62, s62, s53
    s_lshl_b32 s62, s62, 3
    s_add_u32 s62, s62, s60
    s_lshl_b32 s62, s62, 18
    s_and_b32 s61, s61, 0x20000
    s_add_u32 s61, s61, s62
    buffer_load_dwordx4 v24, s[36:39], s61 offen offset:0  lds
    buffer_load_dwordx4 v25, s[36:39], s61 offen offset:1024  lds
    buffer_load_dwordx4 v26, s[36:39], s61 offen offset:2048  lds
    buffer_load_dwordx4 v27, s[36:39], s61 offen offset:3072  lds
    s_waitcnt vmcnt(8)
    s_barrier
    s_waitcnt vmcnt(4)
    s_barrier
    s_waitcnt vmcnt(0)
    s_barrier
    s_endpgm
L_late:
    s_waitcnt vmcnt(10)
    s_barrier
    s_add_u32 s60, s71, 2
    s_add_u32 m0, s70, 32768
    s_and_b32 s60, s60, 15
    s_lshr_b32 s61, s60, 2
    s_xor_b32 s60, s60, s61
    s_lshl_b32 s61, s60, 19
    buffer_load_dwordx4 v14, s[32:35], s61 offen offset:0  lds
    buffer_load_dwordx4 v15, s[32:35], s61 offen offset:1024  lds
    buffer_load_dwordx4 v16, s[32:35], s61 offen offset:2048  lds
    buffer_load_dwordx4 v17, s[32:35], s61 offen offset:3072  lds
    s_add_u32 m0, s69, 114688
    s_lshl_b32 s60, s60, 7
    buffer_load_dwordx4 v8, s[20:23], s60 offen offset:0  lds
    buffer_load_dwordx4 v9, s[20:23], s60 offen offset:1024  lds
    buffer_load_dwordx4 v10, s[20:23], s60 offen offset:2048  lds
    buffer_load_dwordx4 v11, s[20:23], s60 offen offset:3072  lds
    s_add_u32 m0, s69, 118784
    s_nop 0
    buffer_load_dwordx4 v12, s[20:23], s60 offen offset:0  lds
    buffer_load_dwordx4 v13, s[20:23], s60 offen offset:1024  lds
    s_add_u32 s60, s71, 3
    s_add_u32 m0, s70, 49152
    s_and_b32 s60, s60, 15
    s_lshr_b32 s61, s60, 2
    s_xor_b32 s60, s60, s61
    s_lshl_b32 s61, s60, 19
    buffer_load_dwordx4 v14, s[32:35], s61 offen offset:0  lds
    buffer_load_dwordx4 v15, s[32:35], s61 offen offset:1024  lds
    buffer_load_dwordx4 v16, s[32:35], s61 offen offset:2048  lds
    buffer_load_dwordx4 v17, s[32:35], s61 offen offset:3072  lds
    s_add_u32 m0, s69, 139264
    s_lshl_b32 s60, s60, 7
    buffer_load_dwordx4 v8, s[20:23], s60 offen offset:0  lds
    buffer_load_dwordx4 v9, s[20:23], s60 offen offset:1024  lds
    buffer_load_dwordx4 v10, s[20:23], s60 offen offset:2048  lds
    buffer_load_dwordx4 v11, s[20:23], s60 offen offset:3072  lds
    s_add_u32 m0, s69, 143360
    s_nop 0
    buffer_load_dwordx4 v12, s[20:23], s60 offen offset:0  lds
    buffer_load_dwordx4 v13, s[20:23], s60 offen offset:1024  lds
    s_waitcnt vmcnt(20)
    s_barrier
    s_add_u32 s60, s71, 4
    s_add_u32 m0, s70, 0
    s_and_b32 s60, s60, 15
    s_lshr_b32 s61, s60, 2
    s_xor_b32 s60, s60, s61
    s_lshl_b32 s61, s60, 19
    buffer_load_dwordx4 v14, s[32:35], s61 offen offset:0  lds
    buffer_load_dwordx4 v15, s[32:35], s61 offen offset:1024  lds
    buffer_load_dwordx4 v16, s[32:35], s61 offen offset:2048  lds
    buffer_load_dwordx4 v17, s[32:35], s61 offen offset:3072  lds
    s_add_u32 m0, s69, 65536
    s_lshl_b32 s60, s60, 7
    buffer_load_dwordx4 v8, s[20:23], s60 offen offset:0  lds
    buffer_load_dwordx4 v9, s[20:23], s60 offen offset:1024  lds
    buffer_load_dwordx4 v10, s[20:23], s60 offen offset:2048  lds
    buffer_load_dwordx4 v11, s[20:23], s60 offen offset:3072  lds
    s_add_u32 m0, s69, 69632
    s_nop 0
    buffer_load_dwordx4 v12, s[20:23], s60 offen offset:0  lds
    buffer_load_dwordx4 v13, s[20:23], s60 offen offset:1024  lds
    s_waitcnt vmcnt(20)
    s_barrier
    s_add_u32 s60, s71, 5
    s_add_u32 m0, s70, 16384
    s_and_b32 s60, s60, 15
    s_lshr_b32 s61, s60, 2
    s_xor_b32 s60, s60, s61
    s_lshl_b32 s61, s60, 19
    buffer_load_dwordx4 v14, s[32:35], s61 offen offset:0  lds
    buffer_load_dwordx4 v15, s[32:35], s61 offen offset:1024  lds
    buffer_load_dwordx4 v16, s[32:35], s61 offen offset:2048  lds
    buffer_load_dwordx4 v17, s[32:35], s61 offen offset:3072  lds
    s_add_u32 m0, s69, 90112
    s_lshl_b32 s60, s60, 7
    buffer_load_dwordx4 v8, s[20:23], s60 offen offset:0  lds
    buffer_load_dwordx4 v9, s[20:23], s60 offen offset:1024  lds
    buffer_load_dwordx4 v10, s[20:23], s60 offen offset:2048  lds
    buffer_load_dwordx4 v11, s[20:23], s60 offen offset:3072  lds
    s_add_u32 m0, s69, 94208
    s_nop 0
    buffer_load_dwordx4 v12, s[20:23], s60 offen offset:0  lds
    buffer_load_dwordx4 v13, s[20:23], s60 offen offset:1024  lds
    s_waitcnt vmcnt(20)
    s_barrier
    s_add_u32 s60, s71, 6
    s_add_u32 m0, s70, 32768
    s_and_b32 s60, s60, 15
    s_lshr_b32 s61, s60, 2
    s_xor_b32 s60, s60, s61
    s_lshl_b32 s61, s60, 19
    buffer_load_dwordx4 v14, s[32:35], s61 offen offset:0  lds
    buffer_load_dwordx4 v15, s[32:35], s61 offen offset:1024  lds
    buffer_load_dwordx4 v16, s[32:35], s61 offen offset:2048  lds
    buffer_load_dwordx4 v17, s[32:35], s61 offen offset:3072  lds
    s_add_u32 m0, s69, 114688
    s_lshl_b32 s60, s60, 7
    buffer_load_dwordx4 v8, s[20:23], s60 offen offset:0  lds
    buffer_load_dwordx4 v9, s[20:23], s60 offen offset:1024  lds
    buffer_load_dwordx4 v10, s[20:23], s60 offen offset:2048  lds
    buffer_load_dwordx4 v11, s[20:23], s60 offen offset:3072  lds
    s_add_u32 m0, s69, 118784
    s_nop 0
    buffer_load_dwordx4 v12, s[20:23], s60 offen offset:0  lds
    buffer_load_dwordx4 v13, s[20:23], s60 offen offset:1024  lds
    s_waitcnt vmcnt(20)
    s_barrier
    s_add_u32 s60, s71, 7
    s_add_u32 m0, s70, 49152
    s_and_b32 s60, s60, 15
    s_lshr_b32 s61, s60, 2
    s_xor_b32 s60, s60, s61
    s_lshl_b32 s61, s60, 19
    buffer_load_dwordx4 v14, s[32:35], s61 offen offset:0  lds
    buffer_load_dwordx4 v15, s[32:35], s61 offen offset:1024  lds
    buffer_load_dwordx4 v16, s[32:35], s61 offen offset:2048  lds
    buffer_load_dwordx4 v17, s[32:35], s61 offen offset:3072  lds
    s_add_u32 m0, s69, 139264
    s_lshl_b32 s60, s60, 7
    buffer_load_dwordx4 v8, s[20:23], s60 offen offset:0  lds
    buffer_load_dwordx4 v9, s[20:23], s60 offen offset:1024  lds
    buffer_load_dwordx4 v10, s[20:23], s60 offen offset:2048  lds
    buffer_load_dwordx4 v11, s[20:23], s60 offen offset:3072  lds
    s_add_u32 m0, s69, 143360
    s_nop 0
    buffer_load_dwordx4 v12, s[20:23], s60 offen offset:0  lds
    buffer_load_dwordx4 v13, s[20:23], s60 offen offset:1024  lds
    s_waitcnt vmcnt(20)
    s_barrier
    s_add_u32 s60, s71, 8
    s_add_u32 m0, s70, 0
    s_and_b32 s60, s60, 15
    s_lshr_b32 s61, s60, 2
    s_xor_b32 s60, s60, s61
    s_lshl_b32 s61, s60, 19
    buffer_load_dwordx4 v14, s[32:35], s61 offen offset:0  lds
    buffer_load_dwordx4 v15, s[32:35], s61 offen offset:1024  lds
    buffer_load_dwordx4 v16, s[32:35], s61 offen offset:2048  lds
    buffer_load_dwordx4 v17, s[32:35], s61 offen offset:3072  lds
    s_add_u32 m0, s69, 65536
    s_lshl_b32 s60, s60, 7
    buffer_load_dwordx4 v8, s[20:23], s60 offen offset:0  lds
    buffer_load_dwordx4 v9, s[20:23], s60 offen offset:1024  lds
    buffer_load_dwordx4 v10, s[20:23], s60 offen offset:2048  lds
    buffer_load_dwordx4 v11, s[20:23], s60 offen offset:3072  lds
    s_add_u32 m0, s69, 69632
    s_nop 0
    buffer_load_dwordx4 v12, s[20:23], s60 offen offset:0  lds
    buffer_load_dwordx4 v13, s[20:23], s60 offen offset:1024  lds
    s_waitcnt vmcnt(20)
    s_barrier
    s_add_u32 s60, s71, 9
    s_add_u32 m0, s70, 16384
    s_and_b32 s60, s60, 15
    s_lshr_b32 s61, s60, 2
    s_xor_b32 s60, s60, s61
    s_lshl_b32 s61, s60, 19
    buffer_load_dwordx4 v14, s[32:35], s61 offen offset:0  lds
    buffer_load_dwordx4 v15, s[32:35], s61 offen offset:1024  lds
    buffer_load_dwordx4 v16, s[32:35], s61 offen offset:2048  lds
    buffer_load_dwordx4 v17, s[32:35], s61 offen offset:3072  lds
    s_add_u32 m0, s69, 90112
    s_lshl_b32 s60, s60, 7
    buffer_load_dwordx4 v8, s[20:23], s60 offen offset:0  lds
    buffer_load_dwordx4 v9, s[20:23], s60 offen offset:1024  lds
    buffer_load_dwordx4 v10, s[20:23], s60 offen offset:2048  lds
    buffer_load_dwordx4 v11, s[20:23], s60 offen offset:3072  lds
    s_add_u32 m0, s69, 94208
    s_nop 0
    buffer_load_dwordx4 v12, s[20:23], s60 offen offset:0  lds
    buffer_load_dwordx4 v13, s[20:23], s60 offen offset:1024  lds
    s_waitcnt vmcnt(20)
    s_barrier
    s_add_u32 s60, s71, 10
    s_add_u32 m0, s70, 32768
    s_and_b32 s60, s60, 15
    s_lshr_b32 s61, s60, 2
    s_xor_b32 s60, s60, s61
    s_lshl_b32 s61, s60, 19
    buffer_load_dwordx4 v14, s[32:35], s61 offen offset:0  lds
    buffer_load_dwordx4 v15, s[32:35], s61 offen offset:1024  lds
    buffer_load_dwordx4 v16, s[32:35], s61 offen offset:2048  lds
    buffer_load_dwordx4 v17, s[32:35], s61 offen offset:3072  lds
    s_add_u32 m0, s69, 114688
    s_lshl_b32 s60, s60, 7
    buffer_load_dwordx4 v8, s[20:23], s60 offen offset:0  lds
    buffer_load_dwordx4 v9, s[20:23], s60 offen offset:1024  lds
    buffer_load_dwordx4 v10, s[20:23], s60 offen offset:2048  lds
    buffer_load_dwordx4 v11, s[20:23], s60 offen offset:3072  lds
    s_add_u32 m0, s69, 118784
    s_nop 0
    buffer_load_dwordx4 v12, s[20:23], s60 offen offset:0  lds
    buffer_load_dwordx4 v13, s[20:23], s60 offen offset:1024  lds
    s_waitcnt vmcnt(20)
    s_barrier
    s_add_u32 s60, s71, 11
    s_add_u32 m0, s70, 49152
    s_and_b32 s60, s60, 15
    s_lshr_b32 s61, s60, 2
    s_xor_b32 s60, s60, s61
    s_lshl_b32 s61, s60, 19
    buffer_load_dwordx4 v14, s[32:35], s61 offen offset:0  lds
    buffer_load_dwordx4 v15, s[32:35], s61 offen offset:1024  lds
    buffer_load_dwordx4 v16, s[32:35], s61 offen offset:2048  lds
    buffer_load_dwordx4 v17, s[32:35], s61 offen offset:3072  lds
    s_add_u32 m0, s69, 139264
    s_lshl_b32 s60, s60, 7
    buffer_load_dwordx4 v8, s[20:23], s60 offen offset:0  lds
    buffer_load_dwordx4 v9, s[20:23], s60 offen offset:1024  lds
    buffer_load_dwordx4 v10, s[20:23], s60 offen offset:2048  lds
    buffer_load_dwordx4 v11, s[20:23], s60 offen offset:3072  lds
    s_add_u32 m0, s69, 143360
    s_nop 0
    buffer_load_dwordx4 v12, s[20:23], s60 offen offset:0  lds
    buffer_load_dwordx4 v13, s[20:23], s60 offen offset:1024  lds
    s_waitcnt vmcnt(20)
    s_barrier
    s_add_u32 s60, s71, 12
    s_add_u32 m0, s70, 0
    s_and_b32 s60, s60, 15
    s_lshr_b32 s61, s60, 2
    s_xor_b32 s60, s60, s61
    s_lshl_b32 s61, s60, 19
    buffer_load_dwordx4 v14, s[32:35], s61 offen offset:0  lds
    buffer_load_dwordx4 v15, s[32:35], s61 offen offset:1024  lds
    buffer_load_dwordx4 v16, s[32:35], s61 offen offset:2048  lds
    buffer_load_dwordx4 v17, s[32:35], s61 offen offset:3072  lds
    s_add_u32 m0, s69, 65536
    s_lshl_b32 s60, s60, 7
    buffer_load_dwordx4 v8, s[20:23], s60 offen offset:0  lds
    buffer_load_dwordx4 v9, s[20:23], s60 offen offset:1024  lds
    buffer_load_dwordx4 v10, s[20:23], s60 offen offset:2048  lds
    buffer_load_dwordx4 v11, s[20:23], s60 offen offset:3072  lds
    s_add_u32 m0, s69, 69632
    s_nop 0
    buffer_load_dwordx4 v12, s[20:23], s60 offen offset:0  lds
    buffer_load_dwordx4 v13, s[20:23], s60 offen offset:1024  lds
    s_waitcnt vmcnt(20)
    s_barrier
    s_add_u32 s60, s71, 13
    s_add_u32 m0, s70, 16384
    s_and_b32 s60, s60, 15
    s_lshr_b32 s61, s60, 2
    s_xor_b32 s60, s60, s61
    s_lshl_b32 s61, s60, 19
    buffer_load_dwordx4 v14, s[32:35], s61 offen offset:0  lds
    buffer_load_dwordx4 v15, s[32:35], s61 offen offset:1024  lds
    buffer_load_dwordx4 v16, s[32:35], s61 offen offset:2048  lds
    buffer_load_dwordx4 v17, s[32:35], s61 offen offset:3072  lds
    s_add_u32 m0, s69, 90112
    s_lshl_b32 s60, s60, 7
    buffer_load_dwordx4 v8, s[20:23], s60 offen offset:0  lds
    buffer_load_dwordx4 v9, s[20:23], s60 offen offset:1024  lds
    buffer_load_dwordx4 v10, s[20:23], s60 offen offset:2048  lds
    buffer_load_dwordx4 v11, s[20:23], s60 offen offset:3072  lds
    s_add_u32 m0, s69, 94208
    s_nop 0
    buffer_load_dwordx4 v12, s[20:23], s60 offen offset:0  lds
    buffer_load_dwordx4 v13, s[20:23], s60 offen offset:1024  lds
    s_waitcnt vmcnt(20)
    s_barrier
    s_add_u32 s60, s71, 14
    s_add_u32 m0, s70, 32768
    s_and_b32 s60, s60, 15
    s_lshr_b32 s61, s60, 2
    s_xor_b32 s60, s60, s61
    s_lshl_b32 s61, s60, 19
    buffer_load_dwordx4 v14, s[32:35], s61 offen offset:0  lds
    buffer_load_dwordx4 v15, s[32:35], s61 offen offset:1024  lds
    buffer_load_dwordx4 v16, s[32:35], s61 offen offset:2048  lds
    buffer_load_dwordx4 v17, s[32:35], s61 offen offset:3072  lds
    s_add_u32 m0, s69, 114688
    s_lshl_b32 s60, s60, 7
    buffer_load_dwordx4 v8, s[20:23], s60 offen offset:0  lds
    buffer_load_dwordx4 v9, s[20:23], s60 offen offset:1024  lds
    buffer_load_dwordx4 v10, s[20:23], s60 offen offset:2048  lds
    buffer_load_dwordx4 v11, s[20:23], s60 offen offset:3072  lds
    s_add_u32 m0, s69, 118784
    s_nop 0
    buffer_load_dwordx4 v12, s[20:23], s60 offen offset:0  lds
    buffer_load_dwordx4 v13, s[20:23], s60 offen offset:1024  lds
    s_waitcnt vmcnt(20)
    s_barrier
    s_add_u32 s60, s71, 15
    s_add_u32 m0, s70, 49152
    s_and_b32 s60, s60, 15
    s_lshr_b32 s61, s60, 2
    s_xor_b32 s60, s60, s61
    s_lshl_b32 s61, s60, 19
    buffer_load_dwordx4 v14, s[32:35], s61 offen offset:0  lds
    buffer_load_dwordx4 v15, s[32:35], s61 offen offset:1024  lds
    buffer_load_dwordx4 v16, s[32:35], s61 offen offset:2048  lds
    buffer_load_dwordx4 v17, s[32:35], s61 offen offset:3072  lds
    s_add_u32 m0, s69, 139264
    s_lshl_b32 s60, s60, 7
    buffer_load_dwordx4 v8, s[20:23], s60 offen offset:0  lds
    buffer_load_dwordx4 v9, s[20:23], s60 offen offset:1024  lds
    buffer_load_dwordx4 v10, s[20:23], s60 offen offset:2048  lds
    buffer_load_dwordx4 v11, s[20:23], s60 offen offset:3072  lds
    s_add_u32 m0, s69, 143360
    s_nop 0
    buffer_load_dwordx4 v12, s[20:23], s60 offen offset:0  lds
    buffer_load_dwordx4 v13, s[20:23], s60 offen offset:1024  lds
    s_mov_b32 s60, 0
    buffer_load_dwordx4 v[36:39], v18, s[24:27], s60 offen offset:0 nt
    buffer_load_dwordx4 v[40:43], v19, s[24:27], s60 offen offset:1024 nt
    buffer_load_dwordx4 v[44:47], v20, s[24:27], s60 offen offset:2048 nt
    buffer_load_dwordx4 v[48:51], v21, s[24:27], s60 offen offset:3072 nt
    s_mov_b32 s60, 4096
    buffer_load_dwordx4 v[52:55], v18, s[24:27], s60 offen offset:0 nt
    buffer_load_dwordx4 v[56:59], v19, s[24:27], s60 offen offset:1024 nt
    buffer_load_dwordx4 v[60:63], v20, s[24:27], s60 offen offset:2048 nt
    buffer_load_dwordx4 v[64:67], v21, s[24:27], s60 offen offset:3072 nt
    s_mov_b32 s60, 0
    buffer_load_dwordx4 v[68:71], v22, s[28:31], s60 offen offset:0 nt
    buffer_load_dwordx4 v[72:75], v23, s[28:31], s60 offen offset:1024 nt
    buffer_load_dwordx4 v[76:79], v34, s[28:31], s60 offen offset:2048 nt
    buffer_load_dwordx4 v[80:83], v35, s[28:31], s60 offen offset:3072 nt
    s_mov_b32 s60, 1024
    buffer_load_dwordx4 v[84:87], v18, s[24:27], s60 offen offset:0 nt
    buffer_load_dwordx4 v[88:91], v19, s[24:27], s60 offen offset:1024 nt
    buffer_load_dwordx4 v[92:95], v20, s[24:27], s60 offen offset:2048 nt
    buffer_load_dwordx4 v[96:99], v21, s[24:27], s60 offen offset:3072 nt
    s_waitcnt vmcnt(36)
    s_barrier
    s_mov_b32 s60, 4096
    buffer_load_dwordx4 v[100:103], v22, s[28:31], s60 offen offset:0 nt
    buffer_load_dwordx4 v[104:107], v23, s[28:31], s60 offen offset:1024 nt
    buffer_load_dwordx4 v[108:111], v34, s[28:31], s60 offen offset:2048 nt
    buffer_load_dwordx4 v[112:115], v35, s[28:31], s60 offen offset:3072 nt
    s_mov_b32 s60, 5120
    buffer_load_dwordx4 v[116:119], v18, s[24:27], s60 offen offset:0 nt
    buffer_load_dwordx4 v[120:123], v19, s[24:27], s60 offen offset:1024 nt
    buffer_load_dwordx4 v[124:127], v20, s[24:27], s60 offen offset:2048 nt
    buffer_load_dwordx4 v[128:131], v21, s[24:27], s60 offen offset:3072 nt
    s_mov_b32 s60, 1024
    buffer_load_dwordx4 v[132:135], v22, s[28:31], s60 offen offset:0 nt
    buffer_load_dwordx4 v[136:139], v23, s[28:31], s60 offen offset:1024 nt
    buffer_load_dwordx4 v[140:143], v34, s[28:31], s60 offen offset:2048 nt
    buffer_load_dwordx4 v[144:147], v35, s[28:31], s60 offen offset:3072 nt
    s_mov_b32 s60, 32768
    buffer_load_dwordx4 v[148:151], v18, s[24:27], s60 offen offset:0 nt
    buffer_load_dwordx4 v[152:155], v19, s[24:27], s60 offen offset:1024 nt
    s_waitcnt vmcnt(40)
    s_barrier
    s_mov_b32 s60, 32768
    buffer_load_dwordx4 v[156:159], v20, s[24:27], s60 offen offset:2048 nt
    buffer_load_dwordx4 v[160:163], v21, s[24:27], s60 offen offset:3072 nt
    s_mov_b32 s60, 5120
    buffer_load_dwordx4 v[164:167], v22, s[28:31], s60 offen offset:0 nt
    buffer_load_dwordx4 v[168:171], v23, s[28:31], s60 offen offset:1024 nt
    buffer_load_dwordx4 v[172:175], v34, s[28:31], s60 offen offset:2048 nt
    buffer_load_dwordx4 v[176:179], v35, s[28:31], s60 offen offset:3072 nt
    s_mov_b32 s60, 36864
    buffer_load_dwordx4 v[180:183], v18, s[24:27], s60 offen offset:0 nt
    buffer_load_dwordx4 v[184:187], v19, s[24:27], s60 offen offset:1024 nt
    buffer_load_dwordx4 v[188:191], v20, s[24:27], s60 offen offset:2048 nt
    buffer_load_dwordx4 v[192:195], v21, s[24:27], s60 offen offset:3072 nt
    s_mov_b32 s60, 32768
    buffer_load_dwordx4 v[196:199], v22, s[28:31], s60 offen offset:0 nt
    buffer_load_dwordx4 v[200:203], v23, s[28:31], s60 offen offset:1024 nt
    s_waitcnt vmcnt(42)
    s_barrier
    s_mov_b32 s60, 32768
    buffer_load_dwordx4 v[204:207], v34, s[28:31], s60 offen offset:2048 nt
    buffer_load_dwordx4 v[208:211], v35, s[28:31], s60 offen offset:3072 nt
    s_mov_b32 s60, 33792
    buffer_load_dwordx4 v[212:215], v18, s[24:27], s60 offen offset:0 nt
    buffer_load_dwordx4 v[216:219], v19, s[24:27], s60 offen offset:1024 nt
    buffer_load_dwordx4 v[220:223], v20, s[24:27], s60 offen offset:2048 nt
    buffer_load_dwordx4 v[224:227], v21, s[24:27], s60 offen offset:3072 nt
    s_mov_b32 s60, 36864
    buffer_load_dwordx4 v[228:231], v22, s[28:31], s60 offen offset:0 nt
    buffer_load_dwordx4 v[232:235], v23, s[28:31], s60 offen offset:1024 nt
    buffer_load_dwordx4 v[236:239], v34, s[28:31], s60 offen offset:2048 nt
    buffer_load_dwordx4 v[240:243], v35, s[28:31], s60 offen offset:3072 nt
    s_waitcnt vmcnt(51)
    ds_write_b128 v1, v[36:39] offset:0
    s_waitcnt vmcnt(50)
    ds_write_b128 v1, v[40:43] offset:1024
    s_waitcnt vmcnt(49)
    ds_write_b128 v1, v[44:47] offset:2048
    s_waitcnt vmcnt(48)
    ds_write_b128 v1, v[48:51] offset:3072
    s_waitcnt lgkmcnt(0)
    s_barrier
    s_mov_b32 s60, 37888
    s_waitcnt vmcnt(7)
    buffer_load_dwordx4 v[244:247], v18, s[24:27], s60 offen offset:0 nt
    ds_write_b128 v1, v[52:55] offset:16384
    ds_write_b128 v1, v[56:59] offset:17408
    s_waitcnt vmcnt(7)
    buffer_load_dwordx4 v[248:251], v19, s[24:27], s60 offen offset:1024 nt
    ds_write_b128 v1, v[60:63] offset:18432
    ds_write_b128 v1, v[64:67] offset:19456
    s_waitcnt vmcnt(7)
    buffer_load_dwordx4 v[252:255], v20, s[24:27], s60 offen offset:2048 nt
    ds_write_b128 v2, v[68:71] offset:0
    ds_write_b128 v2, v[72:75] offset:1024
    s_waitcnt vmcnt(7)
    buffer_load_dwordx4 v[36:39], v21, s[24:27], s60 offen offset:3072 nt
    ds_write_b128 v2, v[76:79] offset:2048
    ds_write_b128 v2, v[80:83] offset:3072
    s_mov_b32 s60, 33792
    s_waitcnt vmcnt(7)
    buffer_load_dwordx4 v[40:43], v22, s[28:31], s60 offen offset:0 nt
    ds_write_b128 v1, v[84:87] offset:32768
    ds_write_b128 v1, v[88:91] offset:33792
    s_waitcnt vmcnt(7)
    buffer_load_dwordx4 v[44:47], v23, s[28:31], s60 offen offset:1024 nt
    ds_write_b128 v1, v[92:95] offset:34816
    ds_write_b128 v1, v[96:99] offset:35840
    s_waitcnt vmcnt(7)
    buffer_load_dwordx4 v[48:51], v34, s[28:31], s60 offen offset:2048 nt
    ds_write_b128 v2, v[100:103] offset:16384
    ds_write_b128 v2, v[104:107] offset:17408
    s_waitcnt vmcnt(7)
    buffer_load_dwordx4 v[52:55], v35, s[28:31], s60 offen offset:3072 nt
    ds_write_b128 v2, v[108:111] offset:18432
    ds_write_b128 v2, v[112:115] offset:19456
    s_waitcnt lgkmcnt(0)
    s_barrier
    s_mov_b32 s60, 65536
    s_waitcnt vmcnt(4)
    buffer_load_dwordx4 v[56:59], v18, s[24:27], s60 offen offset:0 nt
    ds_write_b128 v1, v[116:119] offset:0
    ds_write_b128 v1, v[120:123] offset:1024
    s_waitcnt vmcnt(4)
    buffer_load_dwordx4 v[60:63], v19, s[24:27], s60 offen offset:1024 nt
    ds_write_b128 v1, v[124:127] offset:2048
    ds_write_b128 v1, v[128:131] offset:3072
    s_waitcnt vmcnt(4)
    buffer_load_dwordx4 v[64:67], v20, s[24:27], s60 offen offset:2048 nt
    ds_write_b128 v2, v[132:135] offset:32768
    ds_write_b128 v2, v[136:139] offset:33792
    s_waitcnt vmcnt(4)
    buffer_load_dwordx4 v[68:71], v21, s[24:27], s60 offen offset:3072 nt
    ds_write_b128 v2, v[140:143] offset:34816
    ds_write_b128 v2, v[144:147] offset:35840
    s_mov_b32 s60, 37888
    s_waitcnt vmcnt(4)
    buffer_load_dwordx4 v[72:75], v22, s[28:31], s60 offen offset:0 nt
    s_waitcnt lgkmcnt(0)
    s_barrier
    s_mov_b32 s60, 37888
    s_waitcnt vmcnt(4)
    buffer_load_dwordx4 v[76:79], v23, s[28:31], s60 offen offset:1024 nt
    ds_write_b128 v1, v[148:151] offset:16384
    ds_write_b128 v1, v[152:155] offset:17408
    s_waitcnt vmcnt(4)
    buffer_load_dwordx4 v[80:83], v34, s[28:31], s60 offen offset:2048 nt
    ds_write_b128 v1, v[156:159] offset:18432
    ds_write_b128 v1, v[160:163] offset:19456
    s_waitcnt vmcnt(4)
    buffer_load_dwordx4 v[84:87], v35, s[28:31], s60 offen offset:3072 nt
    ds_write_b128 v2, v[164:167] offset:0
    ds_write_b128 v2, v[168:171] offset:1024
    s_mov_b32 s60, 69632
    s_waitcnt vmcnt(4)
    buffer_load_dwordx4 v[88:91], v18, s[24:27], s60 offen offset:0 nt
    ds_write_b128 v2, v[172:175] offset:2048
    ds_write_b128 v2, v[176:179] offset:3072
    s_waitcnt vmcnt(4)
    buffer_load_dwordx4 v[92:95], v19, s[24:27], s60 offen offset:1024 nt
    s_waitcnt lgkmcnt(0)
    s_barrier
    s_mov_b32 s60, 69632
    s_waitcnt vmcnt(4)
    buffer_load_dwordx4 v[96:99], v20, s[24:27], s60 offen offset:2048 nt
    ds_write_b128 v1, v[180:183] offset:32768
    ds_write_b128 v1, v[184:187] offset:33792
    s_waitcnt vmcnt(4)
    buffer_load_dwordx4 v[100:103], v21, s[24:27], s60 offen offset:3072 nt
    ds_write_b128 v1, v[188:191] offset:34816
    ds_write_b128 v1, v[192:195] offset:35840
    s_mov_b32 s60, 65536
    s_waitcnt vmcnt(4)
    buffer_load_dwordx4 v[104:107], v22, s[28:31], s60 offen offset:0 nt
    ds_write_b128 v2, v[196:199] offset:16384
    ds_write_b128 v2, v[200:203] offset:17408
    s_waitcnt vmcnt(4)
    buffer_load_dwordx4 v[108:111], v23, s[28:31], s60 offen offset:1024 nt
    ds_write_b128 v2, v[204:207] offset:18432
    ds_write_b128 v2, v[208:211] offset:19456
    s_waitcnt vmcnt(4)
    buffer_load_dwordx4 v[112:115], v34, s[28:31], s60 offen offset:2048 nt
    s_waitcnt lgkmcnt(0)
    s_barrier
    s_mov_b32 s60, 65536
    s_waitcnt vmcnt(4)
    buffer_load_dwordx4 v[116:119], v35, s[28:31], s60 offen offset:3072 nt
    ds_write_b128 v1, v[212:215] offset:0
    ds_write_b128 v1, v[216:219] offset:1024
    s_mov_b32 s60, 66560
    s_waitcnt vmcnt(4)
    buffer_load_dwordx4 v[120:123], v18, s[24:27], s60 offen offset:0 nt
    ds_write_b128 v1, v[220:223] offset:2048
    ds_write_b128 v1, v[224:227] offset:3072
    s_waitcnt vmcnt(4)
    buffer_load_dwordx4 v[124:127], v19, s[24:27], s60 offen offset:1024 nt
    ds_write_b128 v2, v[228:231] offset:32768
    ds_write_b128 v2, v[232:235] offset:33792
    s_waitcnt vmcnt(4)
    buffer_load_dwordx4 v[128:131], v20, s[24:27], s60 offen offset:2048 nt
    ds_write_b128 v2, v[236:239] offset:34816
    ds_write_b128 v2, v[240:243] offset:35840
    s_waitcnt vmcnt(4)
    buffer_load_dwordx4 v[132:135], v21, s[24:27], s60 offen offset:3072 nt
    s_waitcnt lgkmcnt(0)
    s_barrier
    s_mov_b32 s60, 69632
    s_waitcnt vmcnt(4)
    buffer_load_dwordx4 v[136:139], v22, s[28:31], s60 offen offset:0 nt
    ds_write_b128 v1, v[244:247] offset:16384
    ds_write_b128 v1, v[248:251] offset:17408
    s_waitcnt vmcnt(4)
    buffer_load_dwordx4 v[140:143], v23, s[28:31], s60 offen offset:1024 nt
    ds_write_b128 v1, v[252:255] offset:18432
    ds_write_b128 v1, v[36:39] offset:19456
    s_waitcnt vmcnt(4)
    buffer_load_dwordx4 v[144:147], v34, s[28:31], s60 offen offset:2048 nt
    ds_write_b128 v2, v[40:43] offset:0
    ds_write_b128 v2, v[44:47] offset:1024
    s_waitcnt vmcnt(4)
    buffer_load_dwordx4 v[148:151], v35, s[28:31], s60 offen offset:3072 nt
    ds_write_b128 v2, v[48:51] offset:2048
    ds_write_b128 v2, v[52:55] offset:3072
    s_mov_b32 s60, 70656
    s_waitcnt vmcnt(4)
    buffer_load_dwordx4 v[152:155], v18, s[24:27], s60 offen offset:0 nt
    s_waitcnt vmcnt(4)
    buffer_load_dwordx4 v[156:159], v19, s[24:27], s60 offen offset:1024 nt
    s_waitcnt lgkmcnt(0)
    s_barrier
    s_mov_b32 s60, 70656
    s_waitcnt vmcnt(4)
    buffer_load_dwordx4 v[160:163], v20, s[24:27], s60 offen offset:2048 nt
    ds_write_b128 v1, v[56:59] offset:32768
    ds_write_b128 v1, v[60:63] offset:33792
    s_waitcnt vmcnt(4)
    buffer_load_dwordx4 v[164:167], v21, s[24:27], s60 offen offset:3072 nt
    ds_write_b128 v1, v[64:67] offset:34816
    ds_write_b128 v1, v[68:71] offset:35840
    s_mov_b32 s60, 66560
    s_waitcnt vmcnt(4)
    buffer_load_dwordx4 v[168:171], v22, s[28:31], s60 offen offset:0 nt
    ds_write_b128 v2, v[72:75] offset:16384
    ds_write_b128 v2, v[76:79] offset:17408
    s_waitcnt vmcnt(4)
    buffer_load_dwordx4 v[172:175], v23, s[28:31], s60 offen offset:1024 nt
    ds_write_b128 v2, v[80:83] offset:18432
    ds_write_b128 v2, v[84:87] offset:19456
    s_waitcnt vmcnt(4)
    buffer_load_dwordx4 v[176:179], v34, s[28:31], s60 offen offset:2048 nt
    s_waitcnt lgkmcnt(0)
    s_barrier
    s_mov_b32 s60, 66560
    s_waitcnt vmcnt(4)
    buffer_load_dwordx4 v[180:183], v35, s[28:31], s60 offen offset:3072 nt
    ds_write_b128 v1, v[88:91] offset:0
    ds_write_b128 v1, v[92:95] offset:1024
    s_mov_b32 s60, 98304
    s_waitcnt vmcnt(4)
    buffer_load_dwordx4 v[184:187], v18, s[24:27], s60 offen offset:0 nt
    ds_write_b128 v1, v[96:99] offset:2048
    ds_write_b128 v1, v[100:103] offset:3072
    s_waitcnt vmcnt(4)
    buffer_load_dwordx4 v[188:191], v19, s[24:27], s60 offen offset:1024 nt
    ds_write_b128 v2, v[104:107] offset:32768
    ds_write_b128 v2, v[108:111] offset:33792
    s_waitcnt vmcnt(4)
    buffer_load_dwordx4 v[192:195], v20, s[24:27], s60 offen offset:2048 nt
    ds_write_b128 v2, v[112:115] offset:34816
    ds_write_b128 v2, v[116:119] offset:35840
    s_waitcnt vmcnt(4)
    buffer_load_dwordx4 v[196:199], v21, s[24:27], s60 offen offset:3072 nt
    s_waitcnt lgkmcnt(0)
    s_barrier
    s_mov_b32 s60, 70656
    s_waitcnt vmcnt(4)
    buffer_load_dwordx4 v[200:203], v22, s[28:31], s60 offen offset:0 nt
    ds_write_b128 v1, v[120:123] offset:16384
    ds_write_b128 v1, v[124:127] offset:17408
    s_waitcnt vmcnt(4)
    buffer_load_dwordx4 v[204:207], v23, s[28:31], s60 offen offset:1024 nt
    ds_write_b128 v1, v[128:131] offset:18432
    ds_write_b128 v1, v[132:135] offset:19456
    s_waitcnt vmcnt(4)
    buffer_load_dwordx4 v[208:211], v34, s[28:31], s60 offen offset:2048 nt
    ds_write_b128 v2, v[136:139] offset:0
    ds_write_b128 v2, v[140:143] offset:1024
    s_waitcnt vmcnt(4)
    buffer_load_dwordx4 v[212:215], v35, s[28:31], s60 offen offset:3072 nt
    ds_write_b128 v2, v[144:147] offset:2048
    ds_write_b128 v2, v[148:151] offset:3072
    s_mov_b32 s60, 102400
    s_waitcnt vmcnt(4)
    buffer_load_dwordx4 v[216:219], v18, s[24:27], s60 offen offset:0 nt
    s_waitcnt lgkmcnt(0)
    s_barrier
    s_mov_b32 s60, 102400
    s_waitcnt vmcnt(4)
    buffer_load_dwordx4 v[220:223], v19, s[24:27], s60 offen offset:1024 nt
    ds_write_b128 v1, v[152:155] offset:32768
    ds_write_b128 v1, v[156:159] offset:33792
    s_waitcnt vmcnt(4)
    buffer_load_dwordx4 v[224:227], v20, s[24:27], s60 offen offset:2048 nt
    ds_write_b128 v1, v[160:163] offset:34816
    ds_write_b128 v1, v[164:167] offset:35840
    s_waitcnt vmcnt(4)
    buffer_load_dwordx4 v[228:231], v21, s[24:27], s60 offen offset:3072 nt
    ds_write_b128 v2, v[168:171] offset:16384
    ds_write_b128 v2, v[172:175] offset:17408
    s_mov_b32 s60, 98304
    s_waitcnt vmcnt(4)
    buffer_load_dwordx4 v[232:235], v22, s[28:31], s60 offen offset:0 nt
    ds_write_b128 v2, v[176:179] offset:18432
    ds_write_b128 v2, v[180:183] offset:19456
    s_waitcnt vmcnt(4)
    buffer_load_dwordx4 v[236:239], v23, s[28:31], s60 offen offset:1024 nt
    s_waitcnt vmcnt(4)
    buffer_load_dwordx4 v[240:243], v34, s[28:31], s60 offen offset:2048 nt
    s_waitcnt lgkmcnt(0)
    s_barrier
    s_mov_b32 s60, 98304
    s_waitcnt vmcnt(4)
    buffer_load_dwordx4 v[244:247], v35, s[28:31], s60 offen offset:3072 nt
    ds_write_b128 v1, v[184:187] offset:0
    ds_write_b128 v1, v[188:191] offset:1024
    s_mov_b32 s60, 99328
    s_waitcnt vmcnt(4)
    buffer_load_dwordx4 v[248:251], v18, s[24:27], s60 offen offset:0 nt
    ds_write_b128 v1, v[192:195] offset:2048
    ds_write_b128 v1, v[196:199] offset:3072
    s_waitcnt vmcnt(4)
    buffer_load_dwordx4 v[252:255], v19, s[24:27], s60 offen offset:1024 nt
    ds_write_b128 v2, v[200:203] offset:32768
    ds_write_b128 v2, v[204:207] offset:33792
    s_waitcnt vmcnt(4)
    buffer_load_dwordx4 v[36:39], v20, s[24:27], s60 offen offset:2048 nt
    ds_write_b128 v2, v[208:211] offset:34816
    ds_write_b128 v2, v[212:215] offset:35840
    s_waitcnt vmcnt(4)
    buffer_load_dwordx4 v[40:43], v21, s[24:27], s60 offen offset:3072 nt
    buffer_load_dword v31, v29, s[44:47], 0 offen sc1
    s_waitcnt lgkmcnt(0)
    s_barrier
    s_mov_b32 s60, 102400
    s_waitcnt vmcnt(4)
    buffer_load_dwordx4 v[44:47], v22, s[28:31], s60 offen offset:0 nt
    ds_write_b128 v1, v[216:219] offset:16384
    ds_write_b128 v1, v[220:223] offset:17408
    s_waitcnt vmcnt(4)
    buffer_load_dwordx4 v[48:51], v23, s[28:31], s60 offen offset:1024 nt
    ds_write_b128 v1, v[224:227] offset:18432
    ds_write_b128 v1, v[228:231] offset:19456
    s_waitcnt vmcnt(4)
    buffer_load_dwordx4 v[52:55], v34, s[28:31], s60 offen offset:2048 nt
    ds_write_b128 v2, v[232:235] offset:0
    ds_write_b128 v2, v[236:239] offset:1024
    s_waitcnt vmcnt(4)
    buffer_load_dwordx4 v[56:59], v35, s[28:31], s60 offen offset:3072 nt
    ds_write_b128 v2, v[240:243] offset:2048
    ds_write_b128 v2, v[244:247] offset:3072
    s_mov_b32 s60, 103424
    s_waitcnt vmcnt(4)
    buffer_load_dwordx4 v[60:63], v18, s[24:27], s60 offen offset:0 nt
    s_waitcnt lgkmcnt(0)
    s_barrier
    s_mov_b32 s60, 103424
    s_waitcnt vmcnt(4)
    buffer_load_dwordx4 v[64:67], v19, s[24:27], s60 offen offset:1024 nt
    ds_write_b128 v1, v[248:251] offset:32768
    ds_write_b128 v1, v[252:255] offset:33792
    s_waitcnt vmcnt(4)
    buffer_load_dwordx4 v[68:71], v20, s[24:27], s60 offen offset:2048 nt
    ds_write_b128 v1, v[36:39] offset:34816
    ds_write_b128 v1, v[40:43] offset:35840
    s_waitcnt vmcnt(4)
    buffer_load_dwordx4 v[72:75], v21, s[24:27], s60 offen offset:3072 nt
    ds_write_b128 v2, v[44:47] offset:16384
    ds_write_b128 v2, v[48:51] offset:17408
    s_mov_b32 s60, 99328
    s_waitcnt vmcnt(4)
    buffer_load_dwordx4 v[76:79], v22, s[28:31], s60 offen offset:0 nt
    ds_write_b128 v2, v[52:55] offset:18432
    ds_write_b128 v2, v[56:59] offset:19456
    s_waitcnt vmcnt(4)
    buffer_load_dwordx4 v[80:83], v23, s[28:31], s60 offen offset:1024 nt
    s_waitcnt lgkmcnt(0)
    s_barrier
    s_add_u32 m0, s70, 147456
    s_mov_b32 s60, 99328
    s_waitcnt vmcnt(4)
    buffer_load_dwordx4 v34, s[28:31], s60 offen offset:2048 nt lds
    ds_write_b128 v1, v[60:63] offset:0
    ds_write_b128 v1, v[64:67] offset:1024
    s_waitcnt vmcnt(4)
    buffer_load_dwordx4 v35, s[28:31], s60 offen offset:3072 nt lds
    ds_write_b128 v1, v[68:71] offset:2048
    s_mov_b32 s60, 103424
    s_waitcnt vmcnt(4)
    buffer_load_dwordx4 v[84:87], v22, s[28:31], s60 offen offset:0 nt
    ds_write_b128 v1, v[72:75] offset:3072
    s_waitcnt vmcnt(4)
    buffer_load_dwordx4 v[88:91], v23, s[28:31], s60 offen offset:1024 nt
    ds_write_b128 v2, v[76:79] offset:32768
    s_waitcnt vmcnt(4)
    buffer_load_dwordx4 v[92:95], v34, s[28:31], s60 offen offset:2048 nt
    ds_write_b128 v2, v[80:83] offset:33792
    s_waitcnt vmcnt(4)
    buffer_load_dwordx4 v[96:99], v35, s[28:31], s60 offen offset:3072 nt
    s_waitcnt lgkmcnt(0)
    s_barrier
    s_waitcnt vmcnt(4)
    s_barrier
    s_waitcnt vmcnt(3)
    ds_write_b128 v2, v[84:87] offset:0
    s_waitcnt vmcnt(2)
    ds_write_b128 v2, v[88:91] offset:1024
    s_waitcnt vmcnt(1)
    ds_write_b128 v2, v[92:95] offset:2048
    s_waitcnt vmcnt(0)
    ds_write_b128 v2, v[96:99] offset:3072
    s_add_u32 s60, s72, 0
    s_add_u32 m0, s70, 0
    s_and_b32 s60, s60, 15
    s_lshl_b32 s61, s60, 17
    s_lshr_b32 s60, s60, 1
    s_lshr_b32 s62, s60, 1
    s_xor_b32 s62, s62, s53
    s_lshl_b32 s62, s62, 3
    s_add_u32 s62, s62, s60
    s_lshl_b32 s62, s62, 18
    s_and_b32 s61, s61, 0x20000
    s_add_u32 s61, s61, s62
    buffer_load_dwordx4 v24, s[36:39], s61 offen offset:0  lds
    buffer_load_dwordx4 v25, s[36:39], s61 offen offset:1024  lds
    buffer_load_dwordx4 v26, s[36:39], s61 offen offset:2048  lds
    buffer_load_dwordx4 v27, s[36:39], s61 offen offset:3072  lds
    s_add_u32 s60, s72, 1
    s_add_u32 m0, s70, 16384
    s_and_b32 s60, s60, 15
    s_lshl_b32 s61, s60, 17
    s_lshr_b32 s60, s60, 1
    s_lshr_b32 s62, s60, 1
    s_xor_b32 s62, s62, s53
    s_lshl_b32 s62, s62, 3
    s_add_u32 s62, s62, s60
    s_lshl_b32 s62, s62, 18
    s_and_b32 s61, s61, 0x20000
    s_add_u32 s61, s61, s62
    buffer_load_dwordx4 v24, s[36:39], s61 offen offset:0  lds
    buffer_load_dwordx4 v25, s[36:39], s61 offen offset:1024  lds
    buffer_load_dwordx4 v26, s[36:39], s61 offen offset:2048  lds
    buffer_load_dwordx4 v27, s[36:39], s61 offen offset:3072  lds
    s_waitcnt lgkmcnt(0)
    s_barrier
    s_waitcnt vmcnt(0)
    s_barrier
    s_add_u32 s60, s72, 4
    s_add_u32 m0, s70, 32768
    s_and_b32 s60, s60, 15
    s_lshl_b32 s61, s60, 17
    s_lshr_b32 s60, s60, 1
    s_lshr_b32 s62, s60, 1
    s_xor_b32 s62, s62, s53
    s_lshl_b32 s62, s62, 3
    s_add_u32 s62, s62, s60
    s_lshl_b32 s62, s62, 18
    s_and_b32 s61, s61, 0x20000
    s_add_u32 s61, s61, s62
    buffer_load_dwordx4 v24, s[36:39], s61 offen offset:0  lds
    buffer_load_dwordx4 v25, s[36:39], s61 offen offset:1024  lds
    buffer_load_dwordx4 v26, s[36:39], s61 offen offset:2048  lds
    buffer_load_dwordx4 v27, s[36:39], s61 offen offset:3072  lds
    s_add_u32 s60, s72, 8
    s_add_u32 m0, s70, 49152
    s_and_b32 s60, s60, 15
    s_lshl_b32 s61, s60, 17
    s_lshr_b32 s60, s60, 1
    s_lshr_b32 s62, s60, 1
    s_xor_b32 s62, s62, s53
    s_lshl_b32 s62, s62, 3
    s_add_u32 s62, s62, s60
    s_lshl_b32 s62, s62, 18
    s_and_b32 s61, s61, 0x20000
    s_add_u32 s61, s61, s62
    buffer_load_dwordx4 v24, s[36:39], s61 offen offset:0  lds
    buffer_load_dwordx4 v25, s[36:39], s61 offen offset:1024  lds
    buffer_load_dwordx4 v26, s[36:39], s61 offen offset:2048  lds
    buffer_load_dwordx4 v27, s[36:39], s61 offen offset:3072  lds
    s_mov_b32 s77, 0
    s_add_u32 s60, s72, 4
    s_bfe_u32 s61, s60, 0x30001
    s_mov_b32 s73, 0
L_need2b:
    s_bitcmp1_b32 s77, s61
    s_cbranch_scc1 L_need2b_done
    buffer_load_dword v31, v29, s[44:47], 0 offen sc1
    s_add_u32 s73, s73, 1
    s_waitcnt vmcnt(0)
    v_cmp_eq_u32 vcc, 1, v31
    s_mov_b32 s77, vcc_lo
    s_cmp_lt_u32 s73, 400000
    s_cbranch_scc1 L_need2b
L_need2b_done:
    s_add_u32 s60, s72, 8
    s_bfe_u32 s61, s60, 0x30001
    s_mov_b32 s73, 0
L_need3b:
    s_bitcmp1_b32 s77, s61
    s_cbranch_scc1 L_need3b_done
    buffer_load_dword v31, v29, s[44:47], 0 offen sc1
    s_add_u32 s73, s73, 1
    s_waitcnt vmcnt(0)
    v_cmp_eq_u32 vcc, 1, v31
    s_mov_b32 s77, vcc_lo
    s_cmp_lt_u32 s73, 400000
    s_cbranch_scc1 L_need3b
L_need3b_done:
    s_barrier
    s_add_u32 s60, s72, 12
    s_bfe_u32 s61, s60, 0x30001
    s_mov_b32 s73, 0
L_need4b:
    s_bitcmp1_b32 s77, s61
    s_cbranch_scc1 L_need4b_done
    buffer_load_dword v31, v29, s[44:47], 0 offen sc1
    s_add_u32 s73, s73, 1
    s_waitcnt vmcnt(0)
    v_cmp_eq_u32 vcc, 1, v31
    s_mov_b32 s77, vcc_lo
    s_cmp_lt_u32 s73, 400000
    s_cbranch_scc1 L_need4b
L_need4b_done:
    s_waitcnt vmcnt(4)
    s_barrier
    s_add_u32 s60, s72, 12
    s_add_u32 m0, s70, 0
    s_and_b32 s60, s60, 15
    s_lshl_b32 s61, s60, 17
    s_lshr_b32 s60, s60, 1
    s_lshr_b32 s62, s60, 1
    s_xor_b32 s62, s62, s53
    s_lshl_b32 s62, s62, 3
    s_add_u32 s62, s62, s60
    s_lshl_b32 s62, s62, 18
    s_and_b32 s61, s61, 0x20000
    s_add_u32 s61, s61, s62
    buffer_load_dwordx4 v24, s[36:39], s61 offen offset:0  lds
    buffer_load_dwordx4 v25, s[36:39], s61 offen offset:1024  lds
    buffer_load_dwordx4 v26, s[36:39], s61 offen offset:2048  lds
    buffer_load_dwordx4 v27, s[36:39], s61 offen offset:3072  lds
    s_add_u32 s60, s72, 5
    s_add_u32 m0, s70, 16384
    s_and_b32 s60, s60, 15
    s_lshl_b32 s61, s60, 17
    s_lshr_b32 s60, s60, 1
    s_lshr_b32 s62, s60, 1
    s_xor_b32 s62, s62, s53
    s_lshl_b32 s62, s62, 3
    s_add_u32 s62, s62, s60
    s_lshl_b32 s62, s62, 18
    s_and_b32 s61, s61, 0x20000
    s_add_u32 s61, s61, s62
    buffer_load_dwordx4 v24, s[36:39], s61 offen offset:0  lds
    buffer_load_dwordx4 v25, s[36:39], s61 offen offset:1024  lds
    buffer_load_dwordx4 v26, s[36:39], s61 offen offset:2048  lds
    buffer_load_dwordx4 v27, s[36:39], s61 offen offset:3072  lds
    s_waitcnt vmcnt(8)
    s_barrier
    s_add_u32 s60, s72, 9
    s_add_u32 m0, s70, 32768
    s_and_b32 s60, s60, 15
    s_lshl_b32 s61, s60, 17
    s_lshr_b32 s60, s60, 1
    s_lshr_b32 s62, s60, 1
    s_xor_b32 s62, s62, s53
    s_lshl_b32 s62, s62, 3
    s_add_u32 s62, s62, s60
    s_lshl_b32 s62, s62, 18
    s_and_b32 s61, s61, 0x20000
    s_add_u32 s61, s61, s62
    buffer_load_dwordx4 v24, s[36:39], s61 offen offset:0  lds
    buffer_load_dwordx4 v25, s[36:39], s61 offen offset:1024  lds
    buffer_load_dwordx4 v26, s[36:39], s61 offen offset:2048  lds
    buffer_load_dwordx4 v27, s[36:39], s61 offen offset:3072  lds
    s_waitcnt vmcnt(8)
    s_barrier
    s_add_u32 s60, s72, 13
    s_add_u32 m0, s70, 49152
    s_and_b32 s60, s60, 15
    s_lshl_b32 s61, s60, 17
    s_lshr_b32 s60, s60, 1
    s_lshr_b32 s62, s60, 1
    s_xor_b32 s62, s62, s53
    s_lshl_b32 s62, s62, 3
    s_add_u32 s62, s62, s60
    s_lshl_b32 s62, s62, 18
    s_and_b32 s61, s61, 0x20000
    s_add_u32 s61, s61, s62
    buffer_load_dwordx4 v24, s[36:39], s61 offen offset:0  lds
    buffer_load_dwordx4 v25, s[36:39], s61 offen offset:1024  lds
    buffer_load_dwordx4 v26, s[36:39], s61 offen offset:2048  lds
    buffer_load_dwordx4 v27, s[36:39], s61 offen offset:3072  lds
    s_waitcnt vmcnt(8)
    s_barrier
    s_add_u32 s60, s72, 2
    s_add_u32 m0, s70, 0
    s_and_b32 s60, s60, 15
    s_lshl_b32 s61, s60, 17
    s_lshr_b32 s60, s60, 1
    s_lshr_b32 s62, s60, 1
    s_xor_b32 s62, s62, s53
    s_lshl_b32 s62, s62, 3
    s_add_u32 s62, s62, s60
    s_lshl_b32 s62, s62, 18
    s_and_b32 s61, s61, 0x20000
    s_add_u32 s61, s61, s62
    buffer_load_dwordx4 v24, s[36:39], s61 offen offset:0  lds
    buffer_load_dwordx4 v25, s[36:39], s61 offen offset:1024  lds
    buffer_load_dwordx4 v26, s[36:39], s61 offen offset:2048  lds
    buffer_load_dwordx4 v27, s[36:39], s61 offen offset:3072  lds
    s_add_u32 s60, s72, 2
    s_bfe_u32 s61, s60, 0x30001
    s_mov_b32 s73, 0
L_need8b:
    s_bitcmp1_b32 s77, s61
    s_cbranch_scc1 L_need8b_done
    buffer_load_dword v31, v29, s[44:47], 0 offen sc1
    s_add_u32 s73, s73, 1
    s_waitcnt vmcnt(0)
    v_cmp_eq_u32 vcc, 1, v31
    s_mov_b32 s77, vcc_lo
    s_cmp_lt_u32 s73, 400000
    s_cbranch_scc1 L_need8b
L_need8b_done:
    s_waitcnt vmcnt(8)
    s_barrier
    s_add_u32 s60, s72, 6
    s_add_u32 m0, s70, 16384
    s_and_b32 s60, s60, 15
    s_lshl_b32 s61, s60, 17
    s_lshr_b32 s60, s60, 1
    s_lshr_b32 s62, s60, 1
    s_xor_b32 s62, s62, s53
    s_lshl_b32 s62, s62, 3
    s_add_u32 s62, s62, s60
    s_lshl_b32 s62, s62, 18
    s_and_b32 s61, s61, 0x20000
    s_add_u32 s61, s61, s62
    buffer_load_dwordx4 v24, s[36:39], s61 offen offset:0  lds
    buffer_load_dwordx4 v25, s[36:39], s61 offen offset:1024  lds
    buffer_load_dwordx4 v26, s[36:39], s61 offen offset:2048  lds
    buffer_load_dwordx4 v27, s[36:39], s61 offen offset:3072  lds
    s_add_u32 s60, s72, 6
    s_bfe_u32 s61, s60, 0x30001
    s_mov_b32 s73, 0
L_need9b:
    s_bitcmp1_b32 s77, s61
    s_cbranch_scc1 L_need9b_done
    buffer_load_dword v31, v29, s[44:47], 0 offen sc1
    s_add_u32 s73, s73, 1
    s_waitcnt vmcnt(0)
    v_cmp_eq_u32 vcc, 1, v31
    s_mov_b32 s77, vcc_lo
    s_cmp_lt_u32 s73, 400000
    s_cbranch_scc1 L_need9b
L_need9b_done:
    s_waitcnt vmcnt(8)
    s_barrier
    s_add_u32 s60, s72, 10
    s_add_u32 m0, s70, 32768
    s_and_b32 s60, s60, 15
    s_lshl_b32 s61, s60, 17
    s_lshr_b32 s60, s60, 1
    s_lshr_b32 s62, s60, 1
    s_xor_b32 s62, s62, s53
    s_lshl_b32 s62, s62, 3
    s_add_u32 s62, s62, s60
    s_lshl_b32 s62, s62, 18
    s_and_b32 s61, s61, 0x20000
    s_add_u32 s61, s61, s62
    buffer_load_dwordx4 v24, s[36:39], s61 offen offset:0  lds
    buffer_load_dwordx4 v25, s[36:39], s61 offen offset:1024  lds
    buffer_load_dwordx4 v26, s[36:39], s61 offen offset:2048  lds
    buffer_load_dwordx4 v27, s[36:39], s61 offen offset:3072  lds
    s_add_u32 s60, s72, 10
    s_bfe_u32 s61, s60, 0x30001
    s_mov_b32 s73, 0
L_need10b:
    s_bitcmp1_b32 s77, s61
    s_cbranch_scc1 L_need10b_done
    buffer_load_dword v31, v29, s[44:47], 0 offen sc1
    s_add_u32 s73, s73, 1
    s_waitcnt vmcnt(0)
    v_cmp_eq_u32 vcc, 1, v31
    s_mov_b32 s77, vcc_lo
    s_cmp_lt_u32 s73, 400000
    s_cbranch_scc1 L_need10b
L_need10b_done:
    s_waitcnt vmcnt(8)
    s_barrier
    s_add_u32 s60, s72, 14
    s_add_u32 m0, s70, 49152
    s_and_b32 s60, s60, 15
    s_lshl_b32 s61, s60, 17
    s_lshr_b32 s60, s60, 1
    s_lshr_b32 s62, s60, 1
    s_xor_b32 s62, s62, s53
    s_lshl_b32 s62, s62, 3
    s_add_u32 s62, s62, s60
    s_lshl_b32 s62, s62, 18
    s_and_b32 s61, s61, 0x20000
    s_add_u32 s61, s61, s62
    buffer_load_dwordx4 v24, s[36:39], s61 offen offset:0  lds
    buffer_load_dwordx4 v25, s[36:39], s61 offen offset:1024  lds
    buffer_load_dwordx4 v26, s[36:39], s61 offen offset:2048  lds
    buffer_load_dwordx4 v27, s[36:39], s61 offen offset:3072  lds
    s_add_u32 s60, s72, 14
    s_bfe_u32 s61, s60, 0x30001
    s_mov_b32 s73, 0
L_need11b:
    s_bitcmp1_b32 s77, s61
    s_cbranch_scc1 L_need11b_done
    buffer_load_dword v31, v29, s[44:47], 0 offen sc1
    s_add_u32 s73, s73, 1
    s_waitcnt vmcnt(0)
    v_cmp_eq_u32 vcc, 1, v31
    s_mov_b32 s77, vcc_lo
    s_cmp_lt_u32 s73, 400000
    s_cbranch_scc1 L_need11b
L_need11b_done:
    s_waitcnt vmcnt(8)
    s_barrier
    s_add_u32 s60, s72, 3
    s_add_u32 m0, s70, 0
    s_and_b32 s60, s60, 15
    s_lshl_b32 s61, s60, 17
    s_lshr_b32 s60, s60, 1
    s_lshr_b32 s62, s60, 1
    s_xor_b32 s62, s62, s53
    s_lshl_b32 s62, s62, 3
    s_add_u32 s62, s62, s60
    s_lshl_b32 s62, s62, 18
    s_and_b32 s61, s61, 0x20000
    s_add_u32 s61, s61, s62
    buffer_load_dwordx4 v24, s[36:39], s61 offen offset:0  lds
    buffer_load_dwordx4 v25, s[36:39], s61 offen offset:1024  lds
    buffer_load_dwordx4 v26, s[36:39], s61 offen offset:2048  lds
    buffer_load_dwordx4 v27, s[36:39], s61 offen offset:3072  lds
    s_waitcnt vmcnt(8)
    s_barrier
    s_add_u32 s60, s72, 7
    s_add_u32 m0, s70, 16384
    s_and_b32 s60, s60, 15
    s_lshl_b32 s61, s60, 17
    s_lshr_b32 s60, s60, 1
    s_lshr_b32 s62, s60, 1
    s_xor_b32 s62, s62, s53
    s_lshl_b32 s62, s62, 3
    s_add_u32 s62, s62, s60
    s_lshl_b32 s62, s62, 18
    s_and_b32 s61, s61, 0x20000
    s_add_u32 s61, s61, s62
    buffer_load_dwordx4 v24, s[36:39], s61 offen offset:0  lds
    buffer_load_dwordx4 v25, s[36:39], s61 offen offset:1024  lds
    buffer_load_dwordx4 v26, s[36:39], s61 offen offset:2048  lds
    buffer_load_dwordx4 v27, s[36:39], s61 offen offset:3072  lds
    s_waitcnt vmcnt(8)
    s_barrier
    s_add_u32 s60, s72, 11
    s_add_u32 m0, s70, 32768
    s_and_b32 s60, s60, 15
    s_lshl_b32 s61, s60, 17
    s_lshr_b32 s60, s60, 1
    s_lshr_b32 s62, s60, 1
    s_xor_b32 s62, s62, s53
    s_lshl_b32 s62, s62, 3
    s_add_u32 s62, s62, s60
    s_lshl_b32 s62, s62, 18
    s_and_b32 s61, s61, 0x20000
    s_add_u32 s61, s61, s62
    buffer_load_dwordx4 v24, s[36:39], s61 offen offset:0  lds
    buffer_load_dwordx4 v25, s[36:39], s61 offen offset:1024  lds
    buffer_load_dwordx4 v26, s[36:39], s61 offen offset:2048  lds
    buffer_load_dwordx4 v27, s[36:39], s61 offen offset:3072  lds
    s_waitcnt vmcnt(8)
    s_barrier
    s_add_u32 s60, s72, 15
    s_add_u32 m0, s70, 49152
    s_and_b32 s60, s60, 15
    s_lshl_b32 s61, s60, 17
    s_lshr_b32 s60, s60, 1
    s_lshr_b32 s62, s60, 1
    s_xor_b32 s62, s62, s53
    s_lshl_b32 s62, s62, 3
    s_add_u32 s62, s62, s60
    s_lshl_b32 s62, s62, 18
    s_and_b32 s61, s61, 0x20000
    s_add_u32 s61, s61, s62
    buffer_load_dwordx4 v24, s[36:39], s61 offen offset:0  lds
    buffer_load_dwordx4 v25, s[36:39], s61 offen offset:1024  lds
    buffer_load_dwordx4 v26, s[36:39], s61 offen offset:2048  lds
    buffer_load_dwordx4 v27, s[36:39], s61 offen offset:3072  lds
    s_waitcnt vmcnt(8)
    s_barrier
    s_waitcnt vmcnt(4)
    s_barrier
    s_waitcnt vmcnt(0)
    s_barrier
    s_endpgm
L_compute:
    s_getpc_b64 s[78:79]
L_text:
    s_mul_i32 s56, s55, 2
    s_add_u32 s56, s56, s54
    s_and_b32 s56, s56, 7
    s_xor_b32 s56, s56, s52
    s_lshl_b32 s56, s56, 2
    s_lshr_b32 s56, 1935823168, s56
    s_and_b32 s56, s56, 7
    s_and_b32 s76, s2, 7
    s_lshl_b32 s61, s55, 3
    s_add_u32 s76, s76, s61
    s_waitcnt lgkmcnt(0)
    s_mov_b32 s20, s4
    s_mov_b32 s21, s5
    s_mov_b32 s22, 1572864
    s_mov_b32 s23, 0x20000
    s_lshr_b32 s60, s2, 3
    s_lshl_b32 s60, s60, 2
    s_add_u32 s60, s60, s53
    s_lshl_b32 s60, s60, 2
    s_add_u32 s60, s60, s57
    s_mul_i32 s60, s60, 3072
    v_min_u32 v112, 23, v0
    v_lshlrev_b32 v112, 7, v112
    buffer_load_dword v113, v112, s[20:23], s60 offen
    s_mov_b32 s40, s14
    s_mov_b32 s41, s15
    s_mov_b32 s42, 3145728
    s_mov_b32 s43, 0x20000
    s_mov_b32 s44, s18
    s_mov_b32 s45, s19
    s_mov_b32 s46, 268435456
    s_mov_b32 s47, 0x20000
    s_mov_b32 s48, s16
    s_mov_b32 s49, s17
    s_mov_b32 s50, 256
    s_mov_b32 s51, 0x20000
    s_getreg_b32 s75, hwreg(HW_REG_XCC_ID, 0, 3)
    s_cmp_lg_u32 s57, 0
    s_cbranch_scc1 L_noclear
    s_lshl_b32 s60, s2, 11
    s_add_u32 s60, s60, 50331648
    v_lshlrev_b32_e64 v1, 4, v0
    v_mov_b64 v[4:5], 0
    v_mov_b64 v[6:7], 0
    buffer_store_dwordx4 v[4:7], v1, s[44:47], s60 offen sc1
    buffer_store_dwordx4 v[4:7], v1, s[44:47], s60 offen offset:1024 sc1
    s_lshr_b32 s60, s2, 3
    s_lshl_b32 s60, s60, 10
    v_and_b32_e64 v110, 7, v0
    v_lshl_add_u32 v110, v110, 7, s60
    v_min_u32 v110, L_text_end-L_text-4, v110
    global_load_dword v111, v110, s[78:79]
L_noclear:
    s_lshl_b32 s75, s75, 2
    v_and_b32 v243, 3, v0
    v_xor_b32 v243, s76, v243
    v_lshlrev_b32 v243, 2, v243
    v_lshrrev_b32 v100, 4, v0
    v_and_b32 v101, 15, v0
    v_bfe_u32 v102, v0, 2, 2
    v_bfe_u32 v103, v0, 1, 1
    v_and_b32 v104, 1, v0
    v_lshlrev_b32 v109, 4, v0
    v_lshl_add_u32 v105, v100, 3, v102
    v_lshlrev_b32_e64 v105, 8, v105
    v_lshl_add_u32 v105, v104, 3, v105
    v_lshl_add_u32 v105, v103, 4, v105
    v_and_b32_e64 v106, 1, v100
    v_lshl_add_u32 v106, v106, 2, v102
    v_lshl_add_u32 v232, v106, 5, v105
    v_xor_b32 v233, 32, v232
    v_xor_b32 v234, 64, v232
    v_xor_b32 v235, 96, v232
    v_xor_b32 v236, 128, v232
    v_xor_b32 v237, 160, v232
    v_xor_b32 v238, 192, v232
    v_xor_b32 v239, 224, v232
    s_add_u32 s60, s69, 65536
    v_lshl_add_u32 v105, v101, 7, s60
    v_lshrrev_b32 v107, 1, v101
    v_xor_b32 v107, v107, v100
    v_lshl_add_u32 v240, v107, 4, v105
    v_xor_b32_e64 v241, 64, v240
    s_lshr_b32 s60, s57, 1
    s_lshl_b32 s60, s60, 13
    s_add_u32 s60, s60, 65536
    v_lshl_add_u32 v105, v101, 8, s60
    v_lshrrev_b32 v107, 1, v100
    v_and_b32 v108, 1, v100
    v_lshl_add_u32 v107, v108, 1, v107
    v_xor_b32_e64 v107, v107, v101
    v_lshl_add_u32 v244, v107, 4, v105
    v_xor_b32_e64 v245, 64, v244
    v_xor_b32 v246, 128, v244
    v_xor_b32 v247, 192, v244
    s_add_u32 s60, s60, 49152
    v_lshl_add_u32 v105, v100, 2, v102
    v_lshl_add_u32 v105, v105, 8, s60
    v_lshl_add_u32 v105, v104, 3, v105
    v_lshl_add_u32 v105, v103, 4, v105
    v_lshl_add_u32 v248, v106, 5, v105
    v_xor_b32 v249, 32, v248
    v_xor_b32 v250, 64, v248
    v_xor_b32 v251, 96, v248
    v_xor_b32 v252, 128, v248
    v_xor_b32 v253, 160, v248
    v_xor_b32 v254, 192, v248
    v_xor_b32 v255, 224, v248
    s_mov_b32 s66, 0x3e0293ee
    s_mov_b32 s67, s66
    s_mov_b32 s62, -49152
    s_mov_b32 s63, -73728
    s_mov_b32 s68, 0
    v_pk_mov_b32 v[0:1], 0, 0
    v_pk_mov_b32 v[2:3], 0, 0
    v_pk_mov_b32 v[4:5], 0, 0
    v_pk_mov_b32 v[6:7], 0, 0
    v_pk_mov_b32 v[8:9], 0, 0
    v_pk_mov_b32 v[10:11], 0, 0
    v_pk_mov_b32 v[12:13], 0, 0
    v_pk_mov_b32 v[14:15], 0, 0
    v_pk_mov_b32 v[16:17], 0, 0
    v_pk_mov_b32 v[18:19], 0, 0
    v_pk_mov_b32 v[20:21], 0, 0
    v_pk_mov_b32 v[22:23], 0, 0
    v_pk_mov_b32 v[24:25], 0, 0
    v_pk_mov_b32 v[26:27], 0, 0
    v_pk_mov_b32 v[28:29], 0, 0
    v_pk_mov_b32 v[30:31], 0, 0
    v_pk_mov_b32 v[32:33], 0, 0
    v_pk_mov_b32 v[34:35], 0, 0
    v_pk_mov_b32 v[36:37], 0, 0
    v_pk_mov_b32 v[38:39], 0, 0
    v_pk_mov_b32 v[40:41], 0, 0
    v_pk_mov_b32 v[42:43], 0, 0
    v_pk_mov_b32 v[44:45], 0, 0
    v_pk_mov_b32 v[46:47], 0, 0
    v_pk_mov_b32 v[48:49], 0, 0
    v_pk_mov_b32 v[50:51], 0, 0
    v_pk_mov_b32 v[52:53], 0, 0
    v_pk_mov_b32 v[54:55], 0, 0
    v_pk_mov_b32 v[56:57], 0, 0
    v_pk_mov_b32 v[58:59], 0, 0
    v_pk_mov_b32 v[60:61], 0, 0
    v_pk_mov_b32 v[62:63], 0, 0
    v_pk_mov_b32 v[64:65], 0, 0
    v_pk_mov_b32 v[66:67], 0, 0
    v_pk_mov_b32 v[68:69], 0, 0
    v_pk_mov_b32 v[70:71], 0, 0
    v_pk_mov_b32 v[72:73], 0, 0
    v_pk_mov_b32 v[74:75], 0, 0
    v_pk_mov_b32 v[76:77], 0, 0
    v_pk_mov_b32 v[78:79], 0, 0
    v_pk_mov_b32 v[80:81], 0, 0
    v_pk_mov_b32 v[82:83], 0, 0
    v_pk_mov_b32 v[84:85], 0, 0
    v_pk_mov_b32 v[86:87], 0, 0
    v_pk_mov_b32 v[88:89], 0, 0
    v_pk_mov_b32 v[90:91], 0, 0
    v_pk_mov_b32 v[92:93], 0, 0
    v_pk_mov_b32 v[94:95], 0, 0
    s_lshr_b32 s60, s2, 4
    s_and_b32 s60, s60, 0
    s_sub_u32 s60, 13, s60
    s_cmp_eq_u32 s57, 0
    s_cselect_b32 s74, s60, 0
    s_barrier
    ds_read_b128 v[176:179], v240 offset:0
    ds_read_b128 v[180:183], v240 offset:2048
    ds_read_b128 v[184:187], v240 offset:4096
    ds_read_b64_tr_b16 v[144:145], v232 offset:0
    ds_read_b64_tr_b16 v[146:147], v232 offset:1024
    ds_read_b64_tr_b16 v[148:149], v233 offset:0
    ds_read_b64_tr_b16 v[150:151], v233 offset:1024
    ds_read_b64_tr_b16 v[152:153], v234 offset:0
    ds_read_b64_tr_b16 v[154:155], v234 offset:1024
    ds_read_b64_tr_b16 v[156:157], v235 offset:0
    ds_read_b64_tr_b16 v[158:159], v235 offset:1024
    ds_read_b64_tr_b16 v[160:161], v236 offset:0
    ds_read_b64_tr_b16 v[162:163], v236 offset:1024
    ds_read_b64_tr_b16 v[164:165], v237 offset:0
    ds_read_b64_tr_b16 v[166:167], v237 offset:1024
    ds_read_b64_tr_b16 v[168:169], v238 offset:0
    ds_read_b64_tr_b16 v[170:171], v238 offset:1024
    ds_read_b64_tr_b16 v[172:173], v239 offset:0
    ds_read_b64_tr_b16 v[174:175], v239 offset:1024
    s_mov_b32 s64, 16
    s_waitcnt lgkmcnt(0)
.p2align 6
L_qloop:
    v_mfma_f32_16x16x32_bf16 v[0:3], v[144:147], v[176:179], v[0:3]
    ds_read_b128 v[220:223], v241 offset:0
    s_add_u32 s68, s68, 1
    v_mfma_f32_16x16x32_bf16 v[4:7], v[144:147], v[180:183], v[4:7]
    ds_read_b128 v[224:227], v241 offset:2048
    s_and_b32 s68, s68, 3
    v_mfma_f32_16x16x32_bf16 v[8:11], v[144:147], v[184:187], v[8:11]
    ds_read_b128 v[228:231], v241 offset:4096
    s_cselect_b32 s65, 16384, s62
    v_mfma_f32_16x16x32_bf16 v[20:23], v[148:151], v[184:187], v[20:23]
    ds_read_b64_tr_b16 v[188:189], v232 offset:8192
    s_cselect_b32 s59, 24576, s63
    v_mfma_f32_16x16x32_bf16 v[16:19], v[148:151], v[180:183], v[16:19]
    ds_read_b64_tr_b16 v[190:191], v232 offset:9216
    v_mfma_f32_16x16x32_bf16 v[12:15], v[148:151], v[176:179], v[12:15]
    ds_read_b64_tr_b16 v[192:193], v233 offset:8192
    v_mfma_f32_16x16x32_bf16 v[24:27], v[152:155], v[176:179], v[24:27]
    ds_read_b64_tr_b16 v[194:195], v233 offset:9216
    v_mfma_f32_16x16x32_bf16 v[28:31], v[152:155], v[180:183], v[28:31]
    ds_read_b64_tr_b16 v[196:197], v234 offset:8192
    v_mfma_f32_16x16x32_bf16 v[32:35], v[152:155], v[184:187], v[32:35]
    ds_read_b64_tr_b16 v[198:199], v234 offset:9216
    v_mfma_f32_16x16x32_bf16 v[44:47], v[156:159], v[184:187], v[44:47]
    ds_read_b64_tr_b16 v[200:201], v235 offset:8192
    v_mfma_f32_16x16x32_bf16 v[40:43], v[156:159], v[180:183], v[40:43]
    ds_read_b64_tr_b16 v[202:203], v235 offset:9216
    v_mfma_f32_16x16x32_bf16 v[36:39], v[156:159], v[176:179], v[36:39]
    ds_read_b64_tr_b16 v[204:205], v236 offset:8192
    v_mfma_f32_16x16x32_bf16 v[48:51], v[160:163], v[176:179], v[48:51]
    ds_read_b64_tr_b16 v[206:207], v236 offset:9216
    v_add_u32_e64 v240, s59, v240
    v_mfma_f32_16x16x32_bf16 v[52:55], v[160:163], v[180:183], v[52:55]
    ds_read_b64_tr_b16 v[208:209], v237 offset:8192
    v_add_u32_e64 v241, s59, v241
    v_mfma_f32_16x16x32_bf16 v[56:59], v[160:163], v[184:187], v[56:59]
    ds_read_b64_tr_b16 v[210:211], v237 offset:9216
    v_add_u32_e64 v232, s65, v232
    v_mfma_f32_16x16x32_bf16 v[68:71], v[164:167], v[184:187], v[68:71]
    ds_read_b64_tr_b16 v[212:213], v238 offset:8192
    v_add_u32_e64 v233, s65, v233
    v_mfma_f32_16x16x32_bf16 v[64:67], v[164:167], v[180:183], v[64:67]
    ds_read_b64_tr_b16 v[214:215], v238 offset:9216
    v_add_u32_e64 v234, s65, v234
    v_mfma_f32_16x16x32_bf16 v[60:63], v[164:167], v[176:179], v[60:63]
    ds_read_b64_tr_b16 v[216:217], v239 offset:8192
    v_add_u32_e64 v235, s65, v235
    v_mfma_f32_16x16x32_bf16 v[72:75], v[168:171], v[176:179], v[72:75]
    ds_read_b64_tr_b16 v[218:219], v239 offset:9216
    v_add_u32_e64 v236, s65, v236
    v_mfma_f32_16x16x32_bf16 v[76:79], v[168:171], v[180:183], v[76:79]
    v_add_u32_e64 v237, s65, v237
    v_mfma_f32_16x16x32_bf16 v[80:83], v[168:171], v[184:187], v[80:83]
    v_add_u32_e64 v238, s65, v238
    v_mfma_f32_16x16x32_bf16 v[92:95], v[172:175], v[184:187], v[92:95]
    v_add_u32_e64 v239, s65, v239
    v_mfma_f32_16x16x32_bf16 v[88:91], v[172:175], v[180:183], v[88:91]
    s_waitcnt lgkmcnt(0)
    s_barrier
    v_mfma_f32_16x16x32_bf16 v[84:87], v[172:175], v[176:179], v[84:87]
    ds_read_b128 v[176:179], v240 offset:0
    v_mfma_f32_16x16x32_bf16 v[0:3], v[188:191], v[220:223], v[0:3]
    ds_read_b128 v[180:183], v240 offset:2048
    v_mfma_f32_16x16x32_bf16 v[4:7], v[188:191], v[224:227], v[4:7]
    ds_read_b128 v[184:187], v240 offset:4096
    v_mfma_f32_16x16x32_bf16 v[8:11], v[188:191], v[228:231], v[8:11]
    ds_read_b64_tr_b16 v[144:145], v232 offset:0
    v_mfma_f32_16x16x32_bf16 v[20:23], v[192:195], v[228:231], v[20:23]
    ds_read_b64_tr_b16 v[146:147], v232 offset:1024
    v_mfma_f32_16x16x32_bf16 v[16:19], v[192:195], v[224:227], v[16:19]
    ds_read_b64_tr_b16 v[148:149], v233 offset:0
    v_mfma_f32_16x16x32_bf16 v[12:15], v[192:195], v[220:223], v[12:15]
    ds_read_b64_tr_b16 v[150:151], v233 offset:1024
    v_mfma_f32_16x16x32_bf16 v[24:27], v[196:199], v[220:223], v[24:27]
    ds_read_b64_tr_b16 v[152:153], v234 offset:0
    v_mfma_f32_16x16x32_bf16 v[28:31], v[196:199], v[224:227], v[28:31]
    ds_read_b64_tr_b16 v[154:155], v234 offset:1024
    v_mfma_f32_16x16x32_bf16 v[32:35], v[196:199], v[228:231], v[32:35]
    ds_read_b64_tr_b16 v[156:157], v235 offset:0
    v_mfma_f32_16x16x32_bf16 v[44:47], v[200:203], v[228:231], v[44:47]
    ds_read_b64_tr_b16 v[158:159], v235 offset:1024
    v_mfma_f32_16x16x32_bf16 v[40:43], v[200:203], v[224:227], v[40:43]
    ds_read_b64_tr_b16 v[160:161], v236 offset:0
    v_mfma_f32_16x16x32_bf16 v[36:39], v[200:203], v[220:223], v[36:39]
    ds_read_b64_tr_b16 v[162:163], v236 offset:1024
    v_mfma_f32_16x16x32_bf16 v[48:51], v[204:207], v[220:223], v[48:51]
    ds_read_b64_tr_b16 v[164:165], v237 offset:0
    v_mfma_f32_16x16x32_bf16 v[52:55], v[204:207], v[224:227], v[52:55]
    ds_read_b64_tr_b16 v[166:167], v237 offset:1024
    v_mfma_f32_16x16x32_bf16 v[56:59], v[204:207], v[228:231], v[56:59]
    ds_read_b64_tr_b16 v[168:169], v238 offset:0
    v_mfma_f32_16x16x32_bf16 v[68:71], v[208:211], v[228:231], v[68:71]
    ds_read_b64_tr_b16 v[170:171], v238 offset:1024
    v_mfma_f32_16x16x32_bf16 v[64:67], v[208:211], v[224:227], v[64:67]
    ds_read_b64_tr_b16 v[172:173], v239 offset:0
    v_mfma_f32_16x16x32_bf16 v[60:63], v[208:211], v[220:223], v[60:63]
    ds_read_b64_tr_b16 v[174:175], v239 offset:1024
    v_mfma_f32_16x16x32_bf16 v[72:75], v[212:215], v[220:223], v[72:75]
    s_cmp_eq_u32 s64, s74
    v_mfma_f32_16x16x32_bf16 v[76:79], v[212:215], v[224:227], v[76:79]
    s_cbranch_scc1 L_count
L_counted:
    v_mfma_f32_16x16x32_bf16 v[80:83], v[212:215], v[228:231], v[80:83]
    s_sub_u32 s64, s64, 1
    s_cmp_lg_u32 s64, 0
    v_mfma_f32_16x16x32_bf16 v[92:95], v[216:219], v[228:231], v[92:95]
    v_mfma_f32_16x16x32_bf16 v[88:91], v[216:219], v[224:227], v[88:91]
    v_mfma_f32_16x16x32_bf16 v[84:87], v[216:219], v[220:223], v[84:87]
    s_waitcnt lgkmcnt(0)
    s_cbranch_scc1 L_qloop
    ds_read_b128 v[144:147], v244 offset:0
    ds_read_b128 v[148:151], v245 offset:0
    ds_read_b128 v[152:155], v246 offset:0
    ds_read_b128 v[156:159], v247 offset:0
    ds_read_b128 v[160:163], v244 offset:4096
    ds_read_b128 v[164:167], v245 offset:4096
    ds_read_b128 v[168:171], v246 offset:4096
    ds_read_b128 v[172:175], v247 offset:4096
    s_waitcnt vmcnt(0)
    s_nop 0
    v_pk_mul_f32 v[0:1], v[0:1], s[66:67]
    v_pk_mul_f32 v[2:3], v[2:3], s[66:67]
    v_pk_mul_f32 v[4:5], v[4:5], s[66:67]
    v_pk_mul_f32 v[6:7], v[6:7], s[66:67]
    v_pk_mul_f32 v[8:9], v[8:9], s[66:67]
    v_pk_mul_f32 v[10:11], v[10:11], s[66:67]
    v_pk_mul_f32 v[12:13], v[12:13], s[66:67]
    v_pk_mul_f32 v[14:15], v[14:15], s[66:67]
    v_pk_mul_f32 v[16:17], v[16:17], s[66:67]
    v_pk_mul_f32 v[18:19], v[18:19], s[66:67]
    v_pk_mul_f32 v[20:21], v[20:21], s[66:67]
    v_pk_mul_f32 v[22:23], v[22:23], s[66:67]
    v_pk_mul_f32 v[24:25], v[24:25], s[66:67]
    v_pk_mul_f32 v[26:27], v[26:27], s[66:67]
    v_pk_mul_f32 v[28:29], v[28:29], s[66:67]
    v_pk_mul_f32 v[30:31], v[30:31], s[66:67]
    v_pk_mul_f32 v[32:33], v[32:33], s[66:67]
    v_pk_mul_f32 v[34:35], v[34:35], s[66:67]
    v_pk_mul_f32 v[36:37], v[36:37], s[66:67]
    v_pk_mul_f32 v[38:39], v[38:39], s[66:67]
    v_pk_mul_f32 v[40:41], v[40:41], s[66:67]
    v_pk_mul_f32 v[42:43], v[42:43], s[66:67]
    v_pk_mul_f32 v[44:45], v[44:45], s[66:67]
    v_pk_mul_f32 v[46:47], v[46:47], s[66:67]
    v_pk_mul_f32 v[48:49], v[48:49], s[66:67]
    v_pk_mul_f32 v[50:51], v[50:51], s[66:67]
    v_pk_mul_f32 v[52:53], v[52:53], s[66:67]
    v_pk_mul_f32 v[54:55], v[54:55], s[66:67]
    v_pk_mul_f32 v[56:57], v[56:57], s[66:67]
    v_pk_mul_f32 v[58:59], v[58:59], s[66:67]
    v_pk_mul_f32 v[60:61], v[60:61], s[66:67]
    v_pk_mul_f32 v[62:63], v[62:63], s[66:67]
    v_pk_mul_f32 v[64:65], v[64:65], s[66:67]
    v_pk_mul_f32 v[66:67], v[66:67], s[66:67]
    v_pk_mul_f32 v[68:69], v[68:69], s[66:67]
    v_pk_mul_f32 v[70:71], v[70:71], s[66:67]
    v_pk_mul_f32 v[72:73], v[72:73], s[66:67]
    v_pk_mul_f32 v[74:75], v[74:75], s[66:67]
    v_pk_mul_f32 v[76:77], v[76:77], s[66:67]
    v_pk_mul_f32 v[78:79], v[78:79], s[66:67]
    v_pk_mul_f32 v[80:81], v[80:81], s[66:67]
    v_pk_mul_f32 v[82:83], v[82:83], s[66:67]
    v_pk_mul_f32 v[84:85], v[84:85], s[66:67]
    v_pk_mul_f32 v[86:87], v[86:87], s[66:67]
    v_pk_mul_f32 v[88:89], v[88:89], s[66:67]
    v_pk_mul_f32 v[90:91], v[90:91], s[66:67]
    v_pk_mul_f32 v[92:93], v[92:93], s[66:67]
    v_pk_mul_f32 v[94:95], v[94:95], s[66:67]
    v_cvt_pk_bf16_f32 v96, v0, v1
    v_cvt_pk_bf16_f32 v97, v2, v3
    v_cvt_pk_bf16_f32 v100, v4, v5
    v_cvt_pk_bf16_f32 v101, v6, v7
    v_cvt_pk_bf16_f32 v104, v8, v9
    v_cvt_pk_bf16_f32 v105, v10, v11
    v_cvt_pk_bf16_f32 v98, v12, v13
    v_cvt_pk_bf16_f32 v99, v14, v15
    v_cvt_pk_bf16_f32 v102, v16, v17
    v_cvt_pk_bf16_f32 v103, v18, v19
    v_cvt_pk_bf16_f32 v106, v20, v21
    v_cvt_pk_bf16_f32 v107, v22, v23
    v_permlane16_swap_b32 v96, v98
    v_permlane16_swap_b32 v97, v99
    v_permlane16_swap_b32 v100, v102
    v_permlane16_swap_b32 v101, v103
    v_permlane16_swap_b32 v104, v106
    v_permlane16_swap_b32 v105, v107
    s_waitcnt lgkmcnt(7)
    v_mfma_f32_16x16x32_bf16 v[176:179], v[144:147], v[96:99], 0
    v_mbcnt_lo_u32_b32 v243, -1, 0
    v_cvt_pk_bf16_f32 v108, v24, v25
    v_cvt_pk_bf16_f32 v109, v26, v27
    v_cvt_pk_bf16_f32 v112, v28, v29
    v_mfma_f32_16x16x32_bf16 v[180:183], v[144:147], v[100:103], 0
    v_mbcnt_hi_u32_b32 v243, -1, v243
    v_cvt_pk_bf16_f32 v113, v30, v31
    v_cvt_pk_bf16_f32 v116, v32, v33
    v_cvt_pk_bf16_f32 v117, v34, v35
    v_mfma_f32_16x16x32_bf16 v[184:187], v[144:147], v[104:107], 0
    s_mul_i32 s60, s76, 393216
    v_cvt_pk_bf16_f32 v110, v36, v37
    v_cvt_pk_bf16_f32 v111, v38, v39
    v_cvt_pk_bf16_f32 v114, v40, v41
    s_waitcnt lgkmcnt(3)
    v_mfma_f32_16x16x32_bf16 v[188:191], v[160:163], v[96:99], 0
    s_mul_i32 s61, s54, 49152
    v_cvt_pk_bf16_f32 v115, v42, v43
    v_cvt_pk_bf16_f32 v118, v44, v45
    v_cvt_pk_bf16_f32 v119, v46, v47
    v_mfma_f32_16x16x32_bf16 v[192:195], v[160:163], v[100:103], 0
    v_permlane16_swap_b32 v108, v110
    v_permlane16_swap_b32 v109, v111
    v_permlane16_swap_b32 v112, v114
    v_mfma_f32_16x16x32_bf16 v[196:199], v[160:163], v[104:107], 0
    s_add_u32 s60, s60, s61
    v_permlane16_swap_b32 v113, v115
    v_permlane16_swap_b32 v116, v118
    v_permlane16_swap_b32 v117, v119
    v_mfma_f32_16x16x32_bf16 v[176:179], v[148:151], v[108:111], v[176:179]
    s_add_u32 s60, s60, s69
    v_cvt_pk_bf16_f32 v120, v48, v49
    v_cvt_pk_bf16_f32 v121, v50, v51
    v_cvt_pk_bf16_f32 v124, v52, v53
    v_mfma_f32_16x16x32_bf16 v[180:183], v[148:151], v[112:115], v[180:183]
    v_lshl_add_u32 v241, v243, 4, s60
    v_cvt_pk_bf16_f32 v125, v54, v55
    v_cvt_pk_bf16_f32 v128, v56, v57
    v_cvt_pk_bf16_f32 v129, v58, v59
    v_mfma_f32_16x16x32_bf16 v[184:187], v[148:151], v[116:119], v[184:187]
    v_cvt_pk_bf16_f32 v122, v60, v61
    v_cvt_pk_bf16_f32 v123, v62, v63
    v_cvt_pk_bf16_f32 v126, v64, v65
    s_waitcnt lgkmcnt(2)
    v_mfma_f32_16x16x32_bf16 v[188:191], v[164:167], v[108:111], v[188:191]
    s_andn2_b32 s60, s2, 0x38
    v_cvt_pk_bf16_f32 v127, v66, v67
    v_cvt_pk_bf16_f32 v130, v68, v69
    v_cvt_pk_bf16_f32 v131, v70, v71
    v_mfma_f32_16x16x32_bf16 v[192:195], v[164:167], v[112:115], v[192:195]
    s_lshl_b32 s60, s60, 11
    v_permlane16_swap_b32 v120, v122
    v_permlane16_swap_b32 v121, v123
    v_permlane16_swap_b32 v124, v126
    v_mfma_f32_16x16x32_bf16 v[196:199], v[164:167], v[116:119], v[196:199]
    s_lshl_b32 s61, s54, 2
    v_permlane16_swap_b32 v125, v127
    v_permlane16_swap_b32 v128, v130
    v_permlane16_swap_b32 v129, v131
    v_mfma_f32_16x16x32_bf16 v[176:179], v[152:155], v[120:123], v[176:179]
    v_cvt_pk_bf16_f32 v132, v72, v73
    v_cvt_pk_bf16_f32 v133, v74, v75
    v_cvt_pk_bf16_f32 v136, v76, v77
    v_mfma_f32_16x16x32_bf16 v[180:183], v[152:155], v[124:127], v[180:183]
    s_add_u32 s60, s60, s61
    v_cvt_pk_bf16_f32 v137, v78, v79
    v_cvt_pk_bf16_f32 v140, v80, v81
    v_cvt_pk_bf16_f32 v141, v82, v83
    v_mfma_f32_16x16x32_bf16 v[184:187], v[152:155], v[128:131], v[184:187]
    s_lshl_b32 s61, s57, 9
    v_cvt_pk_bf16_f32 v134, v84, v85
    v_cvt_pk_bf16_f32 v135, v86, v87
    v_cvt_pk_bf16_f32 v138, v88, v89
    s_waitcnt lgkmcnt(1)
    v_mfma_f32_16x16x32_bf16 v[188:191], v[168:171], v[120:123], v[188:191]
    s_add_u32 s60, s60, s61
    v_cvt_pk_bf16_f32 v139, v90, v91
    v_cvt_pk_bf16_f32 v142, v92, v93
    v_cvt_pk_bf16_f32 v143, v94, v95
    v_mfma_f32_16x16x32_bf16 v[192:195], v[168:171], v[124:127], v[192:195]
    v_permlane16_swap_b32 v132, v134
    v_permlane16_swap_b32 v133, v135
    v_permlane16_swap_b32 v136, v138
    v_mfma_f32_16x16x32_bf16 v[196:199], v[168:171], v[128:131], v[196:199]
    s_add_u32 s60, s60, 50331648
    v_permlane16_swap_b32 v137, v139
    v_permlane16_swap_b32 v140, v142
    v_permlane16_swap_b32 v141, v143
    v_mfma_f32_16x16x32_bf16 v[176:179], v[156:159], v[132:135], v[176:179]
    v_lshl_add_u32 v231, v243, 14, s60
    v_mov_b64 v[0:1], 0
    v_mov_b64 v[2:3], 0
    v_mfma_f32_16x16x32_bf16 v[180:183], v[156:159], v[136:139], v[180:183]
    v_mov_b32_e64 v242, 1
    v_mov_b64 v[4:5], 0
    v_mov_b64 v[6:7], 0
    v_mfma_f32_16x16x32_bf16 v[184:187], v[156:159], v[140:143], v[184:187]
    v_mov_b64 v[8:9], 0
    v_mov_b64 v[10:11], 0
    s_waitcnt lgkmcnt(0)
    v_mfma_f32_16x16x32_bf16 v[188:191], v[172:175], v[132:135], v[188:191]
    v_mov_b64 v[12:13], 0
    v_mov_b64 v[14:15], 0
    v_mfma_f32_16x16x32_bf16 v[192:195], v[172:175], v[136:139], v[192:195]
    v_mov_b64 v[16:17], 0
    v_mov_b64 v[18:19], 0
    v_mfma_f32_16x16x32_bf16 v[196:199], v[172:175], v[140:143], v[196:199]
    v_mov_b64 v[20:21], 0
    v_mov_b64 v[22:23], 0
    v_mov_b64 v[24:25], 0
    v_mov_b64 v[26:27], 0
    v_mov_b64 v[28:29], 0
    v_mov_b64 v[30:31], 0
    v_mov_b64 v[32:33], 0
    v_mov_b64 v[34:35], 0
    v_mov_b64 v[36:37], 0
    v_mov_b64 v[38:39], 0
    s_nop 0
    v_max3_f32 v232, v176, v177, v178
    v_max3_f32 v233, v180, v181, v182
    v_max3_f32 v234, v184, v185, v186
    v_max3_f32 v232, v179, v188, v232
    v_max3_f32 v233, v183, v192, v233
    v_max3_f32 v234, v187, v196, v234
    v_max3_f32 v232, v189, v190, v232
    v_max3_f32 v233, v193, v194, v233
    v_max3_f32 v234, v197, v198, v234
    v_max_f32 v232, v191, v232
    v_max_f32 v233, v195, v233
    v_max_f32 v234, v199, v234
    v_mov_b32 v235, v232
    v_mov_b32 v236, v233
    v_mov_b32 v237, v234
    v_permlane32_swap_b32 v232, v235
    v_permlane32_swap_b32 v233, v236
    v_permlane32_swap_b32 v234, v237
    v_max_f32 v232, v232, v235
    v_max_f32 v233, v233, v236
    v_max_f32 v234, v234, v237
    v_mov_b32 v235, v232
    v_mov_b32 v236, v233
    v_mov_b32 v237, v234
    v_permlane16_swap_b32 v232, v235
    v_permlane16_swap_b32 v233, v236
    v_permlane16_swap_b32 v234, v237
    v_max_f32 v232, v232, v235
    v_max_f32 v233, v233, v236
    v_max_f32_e64 v234, v234, v237
    v_pk_add_f32 v[176:177], v[176:177], v[232:233] op_sel:[0,0] op_sel_hi:[1,0] neg_lo:[0,1] neg_hi:[0,1]
    v_pk_add_f32 v[178:179], v[178:179], v[232:233] op_sel:[0,0] op_sel_hi:[1,0] neg_lo:[0,1] neg_hi:[0,1]
    v_pk_add_f32 v[180:181], v[180:181], v[232:233] op_sel:[0,1] op_sel_hi:[1,1] neg_lo:[0,1] neg_hi:[0,1]
    v_pk_add_f32 v[182:183], v[182:183], v[232:233] op_sel:[0,1] op_sel_hi:[1,1] neg_lo:[0,1] neg_hi:[0,1]
    v_pk_add_f32 v[184:185], v[184:185], v[234:235] op_sel:[0,0] op_sel_hi:[1,0] neg_lo:[0,1] neg_hi:[0,1]
    v_pk_add_f32 v[186:187], v[186:187], v[234:235] op_sel:[0,0] op_sel_hi:[1,0] neg_lo:[0,1] neg_hi:[0,1]
    v_pk_add_f32 v[188:189], v[188:189], v[232:233] op_sel:[0,0] op_sel_hi:[1,0] neg_lo:[0,1] neg_hi:[0,1]
    v_pk_add_f32 v[190:191], v[190:191], v[232:233] op_sel:[0,0] op_sel_hi:[1,0] neg_lo:[0,1] neg_hi:[0,1]
    v_pk_add_f32 v[192:193], v[192:193], v[232:233] op_sel:[0,1] op_sel_hi:[1,1] neg_lo:[0,1] neg_hi:[0,1]
    v_pk_add_f32 v[194:195], v[194:195], v[232:233] op_sel:[0,1] op_sel_hi:[1,1] neg_lo:[0,1] neg_hi:[0,1]
    v_pk_add_f32 v[196:197], v[196:197], v[234:235] op_sel:[0,0] op_sel_hi:[1,0] neg_lo:[0,1] neg_hi:[0,1]
    v_pk_add_f32 v[198:199], v[198:199], v[234:235] op_sel:[0,0] op_sel_hi:[1,0] neg_lo:[0,1] neg_hi:[0,1]
    v_sub_f32 v212, 0, v232
    v_sub_f32 v213, 0, v232
    v_sub_f32 v214, 0, v232
    v_sub_f32 v215, 0, v232
    v_sub_f32 v216, 0, v233
    v_sub_f32 v217, 0, v233
    v_sub_f32 v218, 0, v233
    v_sub_f32 v219, 0, v233
    v_sub_f32 v220, 0, v234
    v_sub_f32 v221, 0, v234
    v_sub_f32 v222, 0, v234
    v_sub_f32 v223, 0, v234
    v_mov_b64 v[224:225], 0
    v_mov_b64 v[226:227], 0
    v_mov_b64 v[228:229], 0
    v_exp_f32 v176, v176
    v_exp_f32 v177, v177
    v_exp_f32 v180, v180
    v_exp_f32 v181, v181
    v_exp_f32 v184, v184
    v_exp_f32 v185, v185
    v_exp_f32 v178, v178
    v_exp_f32 v179, v179
    v_exp_f32 v182, v182
    v_exp_f32 v183, v183
    v_exp_f32 v186, v186
    v_exp_f32 v187, v187
    v_exp_f32 v188, v188
    v_exp_f32 v189, v189
    v_exp_f32 v192, v192
    v_exp_f32 v193, v193
    v_exp_f32 v196, v196
    v_exp_f32 v197, v197
    s_barrier
    ds_read_b128 v[144:147], v244 offset:16384
    ds_read_b128 v[148:151], v245 offset:16384
    ds_read_b128 v[152:155], v246 offset:16384
    ds_read_b128 v[156:159], v247 offset:16384
    ds_read_b128 v[160:163], v244 offset:20480
    ds_read_b128 v[164:167], v245 offset:20480
    ds_read_b128 v[168:171], v246 offset:20480
    ds_read_b128 v[172:175], v247 offset:20480
    v_mov_b64 v[40:41], 0
    v_mov_b64 v[42:43], 0
    v_mov_b64 v[44:45], 0
    v_mov_b64 v[46:47], 0
    v_mov_b64 v[48:49], 0
    v_mov_b64 v[50:51], 0
    v_mov_b64 v[52:53], 0
    v_mov_b64 v[54:55], 0
    v_mov_b64 v[56:57], 0
    v_mov_b64 v[58:59], 0
    v_mov_b64 v[60:61], 0
    v_mov_b64 v[62:63], 0
    v_mov_b64 v[64:65], 0
    v_mov_b64 v[66:67], 0
    v_mov_b64 v[68:69], 0
    v_mov_b64 v[70:71], 0
    v_mov_b64 v[72:73], 0
    v_mov_b64 v[74:75], 0
    v_mov_b64 v[76:77], 0
    v_mov_b64 v[78:79], 0
    v_mov_b64 v[80:81], 0
    v_mov_b64 v[82:83], 0
    v_mov_b64 v[84:85], 0
    v_mov_b64 v[86:87], 0
    v_mov_b64 v[88:89], 0
    v_mov_b64 v[90:91], 0
    v_mov_b64 v[92:93], 0
    v_mov_b64 v[94:95], 0
    s_mov_b32 s66, 0x41000000
    s_mov_b32 s64, 5
    s_branch L_aenter
.p2align 6
L_aloop:
    s_cmp_le_u32 s64, 2
    s_cbranch_scc1 L_ahook
L_ahooked:
    s_barrier
    ds_read_b128 v[144:147], v244 offset:16384
    ds_read_b128 v[148:151], v245 offset:16384
    ds_read_b128 v[152:155], v246 offset:16384
    ds_read_b128 v[156:159], v247 offset:16384
    ds_read_b128 v[160:163], v244 offset:20480
    ds_read_b128 v[164:167], v245 offset:20480
    ds_read_b128 v[168:171], v246 offset:20480
    ds_read_b128 v[172:175], v247 offset:20480
L_aenter:
    s_nop 0
    v_pk_add_f32 v[224:225], v[224:225], v[176:177]
    v_pk_add_f32 v[226:227], v[226:227], v[180:181]
    v_pk_add_f32 v[228:229], v[228:229], v[184:185]
    v_pk_add_f32 v[224:225], v[224:225], v[178:179]
    v_pk_add_f32 v[226:227], v[226:227], v[182:183]
    v_pk_add_f32 v[228:229], v[228:229], v[186:187]
    v_pk_add_f32 v[224:225], v[224:225], v[188:189]
    v_pk_add_f32 v[226:227], v[226:227], v[192:193]
    v_pk_add_f32 v[228:229], v[228:229], v[196:197]
    v_cvt_pk_bf16_f32 v200, v176, v177
    v_cvt_pk_bf16_f32 v204, v180, v181
    v_cvt_pk_bf16_f32 v208, v184, v185
    v_cvt_pk_bf16_f32 v201, v178, v179
    v_cvt_pk_bf16_f32 v205, v182, v183
    v_cvt_pk_bf16_f32 v209, v186, v187
    v_cvt_pk_bf16_f32 v202, v188, v189
    v_cvt_pk_bf16_f32 v206, v192, v193
    v_cvt_pk_bf16_f32 v210, v196, v197
    s_waitcnt lgkmcnt(6)
    v_mfma_f32_16x16x32_bf16 v[176:179], v[144:147], v[96:99], v[212:215]
    v_exp_f32 v190, v190
    v_mfma_f32_16x16x32_bf16 v[180:183], v[144:147], v[100:103], v[216:219]
    v_exp_f32_e64 v191, v191
    v_mfma_f32_16x16x32_bf16 v[184:187], v[144:147], v[104:107], v[220:223]
    v_exp_f32_e64 v194, v194
    v_mfma_f32_16x16x32_bf16 v[176:179], v[148:151], v[108:111], v[176:179]
    v_exp_f32_e64 v195, v195
    v_mfma_f32_16x16x32_bf16 v[180:183], v[148:151], v[112:115], v[180:183]
    v_exp_f32_e64 v198, v198
    v_mfma_f32_16x16x32_bf16 v[184:187], v[148:151], v[116:119], v[184:187]
    s_waitcnt lgkmcnt(0)
    v_exp_f32 v199, v199
    v_mfma_f32_16x16x32_bf16 v[176:179], v[152:155], v[120:123], v[176:179]
    v_add_f32 v224, v224, v190
    v_add_f32 v225, v225, v191
    v_mfma_f32_16x16x32_bf16 v[180:183], v[152:155], v[124:127], v[180:183]
    v_add_f32 v226, v226, v194
    v_add_f32 v227, v227, v195
    v_mfma_f32_16x16x32_bf16 v[184:187], v[152:155], v[128:131], v[184:187]
    ds_read_b64_tr_b16 v[144:145], v248 offset:0
    v_add_f32_e64 v228, v228, v198
    v_mfma_f32_16x16x32_bf16 v[176:179], v[156:159], v[132:135], v[176:179]
    ds_read_b64_tr_b16 v[146:147], v248 offset:4096
    v_add_f32_e64 v229, v229, v199
    v_mfma_f32_16x16x32_bf16 v[180:183], v[156:159], v[136:139], v[180:183]
    ds_read_b64_tr_b16 v[148:149], v249 offset:0
    v_cvt_pk_bf16_f32 v203, v190, v191
    v_mfma_f32_16x16x32_bf16 v[184:187], v[156:159], v[140:143], v[184:187]
    ds_read_b64_tr_b16 v[150:151], v249 offset:4096
    v_cvt_pk_bf16_f32 v207, v194, v195
    v_cvt_pk_bf16_f32 v211, v198, v199
    v_mfma_f32_16x16x32_bf16 v[188:191], v[160:163], v[96:99], v[212:215]
    ds_read_b64_tr_b16 v[152:153], v250 offset:0
    v_mfma_f32_16x16x32_bf16 v[192:195], v[160:163], v[100:103], v[216:219]
    ds_read_b64_tr_b16 v[154:155], v250 offset:4096
    v_mfma_f32_16x16x32_bf16 v[196:199], v[160:163], v[104:107], v[220:223]
    ds_read_b64_tr_b16 v[156:157], v251 offset:0
    v_mfma_f32_16x16x32_bf16 v[188:191], v[164:167], v[108:111], v[188:191]
    ds_read_b64_tr_b16 v[158:159], v251 offset:4096
    v_mfma_f32_16x16x32_bf16 v[192:195], v[164:167], v[112:115], v[192:195]
    ds_read_b64_tr_b16 v[160:161], v252 offset:0
    v_max3_f32 v230, v176, v177, v178
    v_mfma_f32_16x16x32_bf16 v[196:199], v[164:167], v[116:119], v[196:199]
    ds_read_b64_tr_b16 v[162:163], v252 offset:4096
    v_max3_f32 v230, v179, v180, v230
    v_mfma_f32_16x16x32_bf16 v[188:191], v[168:171], v[120:123], v[188:191]
    ds_read_b64_tr_b16 v[164:165], v253 offset:0
    v_max3_f32 v230, v181, v182, v230
    v_mfma_f32_16x16x32_bf16 v[192:195], v[168:171], v[124:127], v[192:195]
    ds_read_b64_tr_b16 v[166:167], v253 offset:4096
    v_max3_f32 v230, v183, v184, v230
    v_mfma_f32_16x16x32_bf16 v[196:199], v[168:171], v[128:131], v[196:199]
    ds_read_b64_tr_b16 v[168:169], v254 offset:0
    v_max3_f32 v230, v185, v186, v230
    v_mfma_f32_16x16x32_bf16 v[188:191], v[172:175], v[132:135], v[188:191]
    ds_read_b64_tr_b16 v[170:171], v254 offset:4096
    v_max_f32_e64 v230, v187, v230
    v_mfma_f32_16x16x32_bf16 v[192:195], v[172:175], v[136:139], v[192:195]
    s_waitcnt lgkmcnt(4)
    v_mfma_f32_16x16x32_bf16 v[196:199], v[172:175], v[140:143], v[196:199]
    ds_read_b64_tr_b16 v[172:173], v255 offset:0
    v_mfma_f32_16x16x32_bf16 v[0:3], v[144:147], v[200:203], v[0:3]
    ds_read_b64_tr_b16 v[174:175], v255 offset:4096
    v_mfma_f32_16x16x32_bf16 v[4:7], v[144:147], v[204:207], v[4:7]
    v_max3_f32 v230, v188, v189, v230
    v_max3_f32 v230, v190, v191, v230
    v_mfma_f32_16x16x32_bf16 v[8:11], v[144:147], v[208:211], v[8:11]
    v_max3_f32 v230, v192, v193, v230
    v_max3_f32 v230, v194, v195, v230
    v_mfma_f32_16x16x32_bf16 v[20:23], v[148:151], v[208:211], v[20:23]
    v_max3_f32 v230, v196, v197, v230
    v_max3_f32 v230, v198, v199, v230
    v_mfma_f32_16x16x32_bf16 v[16:19], v[148:151], v[204:207], v[16:19]
    v_cmp_lt_f32 vcc, s66, v230
    v_mfma_f32_16x16x32_bf16 v[12:15], v[148:151], v[200:203], v[12:15]
    s_cbranch_vccnz L_up_0
    v_mfma_f32_16x16x32_bf16 v[24:27], v[152:155], v[200:203], v[24:27]
    v_exp_f32 v176, v176
    v_mfma_f32_16x16x32_bf16 v[28:31], v[152:155], v[204:207], v[28:31]
    v_exp_f32_e64 v177, v177
    v_mfma_f32_16x16x32_bf16 v[32:35], v[152:155], v[208:211], v[32:35]
    v_exp_f32_e64 v180, v180
    v_mfma_f32_16x16x32_bf16 v[44:47], v[156:159], v[208:211], v[44:47]
    v_exp_f32_e64 v181, v181
    v_mfma_f32_16x16x32_bf16 v[40:43], v[156:159], v[204:207], v[40:43]
    v_exp_f32_e64 v184, v184
    v_mfma_f32_16x16x32_bf16 v[36:39], v[156:159], v[200:203], v[36:39]
    s_waitcnt lgkmcnt(0)
    v_exp_f32 v185, v185
    v_mfma_f32_16x16x32_bf16 v[48:51], v[160:163], v[200:203], v[48:51]
    v_exp_f32_e64 v178, v178
    v_mfma_f32_16x16x32_bf16 v[52:55], v[160:163], v[204:207], v[52:55]
    v_exp_f32_e64 v179, v179
    v_mfma_f32_16x16x32_bf16 v[56:59], v[160:163], v[208:211], v[56:59]
    v_exp_f32_e64 v182, v182
    v_mfma_f32_16x16x32_bf16 v[68:71], v[164:167], v[208:211], v[68:71]
    v_exp_f32_e64 v183, v183
    v_mfma_f32_16x16x32_bf16 v[64:67], v[164:167], v[204:207], v[64:67]
    v_exp_f32_e64 v186, v186
    v_mfma_f32_16x16x32_bf16 v[60:63], v[164:167], v[200:203], v[60:63]
    v_exp_f32_e64 v187, v187
    v_mfma_f32_16x16x32_bf16 v[72:75], v[168:171], v[200:203], v[72:75]
    v_exp_f32_e64 v188, v188
    v_mfma_f32_16x16x32_bf16 v[76:79], v[168:171], v[204:207], v[76:79]
    v_exp_f32_e64 v189, v189
    v_mfma_f32_16x16x32_bf16 v[80:83], v[168:171], v[208:211], v[80:83]
    v_exp_f32_e64 v192, v192
    v_mfma_f32_16x16x32_bf16 v[92:95], v[172:175], v[208:211], v[92:95]
    v_exp_f32_e64 v193, v193
    v_mfma_f32_16x16x32_bf16 v[88:91], v[172:175], v[204:207], v[88:91]
    v_exp_f32_e64 v196, v196
    v_mfma_f32_16x16x32_bf16 v[84:87], v[172:175], v[200:203], v[84:87]
    v_exp_f32 v197, v197
L_back_0:
    s_barrier
    ds_read_b128 v[144:147], v244 offset:32768
    ds_read_b128 v[148:151], v245 offset:32768
    ds_read_b128 v[152:155], v246 offset:32768
    ds_read_b128 v[156:159], v247 offset:32768
    ds_read_b128 v[160:163], v244 offset:36864
    ds_read_b128 v[164:167], v245 offset:36864
    ds_read_b128 v[168:171], v246 offset:36864
    ds_read_b128 v[172:175], v247 offset:36864
    v_pk_add_f32 v[224:225], v[224:225], v[176:177]
    v_pk_add_f32 v[226:227], v[226:227], v[180:181]
    v_pk_add_f32 v[228:229], v[228:229], v[184:185]
    v_pk_add_f32 v[224:225], v[224:225], v[178:179]
    v_pk_add_f32 v[226:227], v[226:227], v[182:183]
    v_pk_add_f32 v[228:229], v[228:229], v[186:187]
    v_pk_add_f32 v[224:225], v[224:225], v[188:189]
    v_pk_add_f32 v[226:227], v[226:227], v[192:193]
    v_pk_add_f32 v[228:229], v[228:229], v[196:197]
    v_cvt_pk_bf16_f32 v200, v176, v177
    v_cvt_pk_bf16_f32 v204, v180, v181
    v_cvt_pk_bf16_f32 v208, v184, v185
    v_cvt_pk_bf16_f32 v201, v178, v179
    v_cvt_pk_bf16_f32 v205, v182, v183
    v_cvt_pk_bf16_f32 v209, v186, v187
    v_cvt_pk_bf16_f32 v202, v188, v189
    v_cvt_pk_bf16_f32 v206, v192, v193
    v_cvt_pk_bf16_f32 v210, v196, v197
    s_waitcnt lgkmcnt(6)
    v_mfma_f32_16x16x32_bf16 v[176:179], v[144:147], v[96:99], v[212:215]
    v_exp_f32 v190, v190
    v_mfma_f32_16x16x32_bf16 v[180:183], v[144:147], v[100:103], v[216:219]
    v_exp_f32_e64 v191, v191
    v_mfma_f32_16x16x32_bf16 v[184:187], v[144:147], v[104:107], v[220:223]
    v_exp_f32_e64 v194, v194
    v_mfma_f32_16x16x32_bf16 v[176:179], v[148:151], v[108:111], v[176:179]
    v_exp_f32_e64 v195, v195
    v_mfma_f32_16x16x32_bf16 v[180:183], v[148:151], v[112:115], v[180:183]
    v_exp_f32_e64 v198, v198
    v_mfma_f32_16x16x32_bf16 v[184:187], v[148:151], v[116:119], v[184:187]
    s_waitcnt lgkmcnt(0)
    v_exp_f32 v199, v199
    v_mfma_f32_16x16x32_bf16 v[176:179], v[152:155], v[120:123], v[176:179]
    v_add_f32 v224, v224, v190
    v_add_f32 v225, v225, v191
    v_mfma_f32_16x16x32_bf16 v[180:183], v[152:155], v[124:127], v[180:183]
    v_add_f32 v226, v226, v194
    v_add_f32 v227, v227, v195
    v_mfma_f32_16x16x32_bf16 v[184:187], v[152:155], v[128:131], v[184:187]
    ds_read_b64_tr_b16 v[144:145], v248 offset:16384
    v_add_f32_e64 v228, v228, v198
    v_mfma_f32_16x16x32_bf16 v[176:179], v[156:159], v[132:135], v[176:179]
    ds_read_b64_tr_b16 v[146:147], v248 offset:20480
    v_add_f32_e64 v229, v229, v199
    v_mfma_f32_16x16x32_bf16 v[180:183], v[156:159], v[136:139], v[180:183]
    ds_read_b64_tr_b16 v[148:149], v249 offset:16384
    v_cvt_pk_bf16_f32 v203, v190, v191
    v_mfma_f32_16x16x32_bf16 v[184:187], v[156:159], v[140:143], v[184:187]
    ds_read_b64_tr_b16 v[150:151], v249 offset:20480
    v_cvt_pk_bf16_f32 v207, v194, v195
    v_cvt_pk_bf16_f32 v211, v198, v199
    v_mfma_f32_16x16x32_bf16 v[188:191], v[160:163], v[96:99], v[212:215]
    ds_read_b64_tr_b16 v[152:153], v250 offset:16384
    v_mfma_f32_16x16x32_bf16 v[192:195], v[160:163], v[100:103], v[216:219]
    ds_read_b64_tr_b16 v[154:155], v250 offset:20480
    v_mfma_f32_16x16x32_bf16 v[196:199], v[160:163], v[104:107], v[220:223]
    ds_read_b64_tr_b16 v[156:157], v251 offset:16384
    v_mfma_f32_16x16x32_bf16 v[188:191], v[164:167], v[108:111], v[188:191]
    ds_read_b64_tr_b16 v[158:159], v251 offset:20480
    v_mfma_f32_16x16x32_bf16 v[192:195], v[164:167], v[112:115], v[192:195]
    ds_read_b64_tr_b16 v[160:161], v252 offset:16384
    v_max3_f32 v230, v176, v177, v178
    v_mfma_f32_16x16x32_bf16 v[196:199], v[164:167], v[116:119], v[196:199]
    ds_read_b64_tr_b16 v[162:163], v252 offset:20480
    v_max3_f32 v230, v179, v180, v230
    v_mfma_f32_16x16x32_bf16 v[188:191], v[168:171], v[120:123], v[188:191]
    ds_read_b64_tr_b16 v[164:165], v253 offset:16384
    v_max3_f32 v230, v181, v182, v230
    v_mfma_f32_16x16x32_bf16 v[192:195], v[168:171], v[124:127], v[192:195]
    ds_read_b64_tr_b16 v[166:167], v253 offset:20480
    v_max3_f32 v230, v183, v184, v230
    v_mfma_f32_16x16x32_bf16 v[196:199], v[168:171], v[128:131], v[196:199]
    ds_read_b64_tr_b16 v[168:169], v254 offset:16384
    v_max3_f32 v230, v185, v186, v230
    v_mfma_f32_16x16x32_bf16 v[188:191], v[172:175], v[132:135], v[188:191]
    ds_read_b64_tr_b16 v[170:171], v254 offset:20480
    v_max_f32_e64 v230, v187, v230
    v_mfma_f32_16x16x32_bf16 v[192:195], v[172:175], v[136:139], v[192:195]
    s_waitcnt lgkmcnt(4)
    v_mfma_f32_16x16x32_bf16 v[196:199], v[172:175], v[140:143], v[196:199]
    ds_read_b64_tr_b16 v[172:173], v255 offset:16384
    v_mfma_f32_16x16x32_bf16 v[0:3], v[144:147], v[200:203], v[0:3]
    ds_read_b64_tr_b16 v[174:175], v255 offset:20480
    v_mfma_f32_16x16x32_bf16 v[4:7], v[144:147], v[204:207], v[4:7]
    v_max3_f32 v230, v188, v189, v230
    v_max3_f32 v230, v190, v191, v230
    v_mfma_f32_16x16x32_bf16 v[8:11], v[144:147], v[208:211], v[8:11]
    v_max3_f32 v230, v192, v193, v230
    v_max3_f32 v230, v194, v195, v230
    v_mfma_f32_16x16x32_bf16 v[20:23], v[148:151], v[208:211], v[20:23]
    v_max3_f32 v230, v196, v197, v230
    v_max3_f32 v230, v198, v199, v230
    v_mfma_f32_16x16x32_bf16 v[16:19], v[148:151], v[204:207], v[16:19]
    v_cmp_lt_f32 vcc, s66, v230
    v_mfma_f32_16x16x32_bf16 v[12:15], v[148:151], v[200:203], v[12:15]
    s_cbranch_vccnz L_up_1
    v_mfma_f32_16x16x32_bf16 v[24:27], v[152:155], v[200:203], v[24:27]
    v_exp_f32 v176, v176
    v_mfma_f32_16x16x32_bf16 v[28:31], v[152:155], v[204:207], v[28:31]
    v_exp_f32_e64 v177, v177
    v_mfma_f32_16x16x32_bf16 v[32:35], v[152:155], v[208:211], v[32:35]
    v_exp_f32_e64 v180, v180
    v_mfma_f32_16x16x32_bf16 v[44:47], v[156:159], v[208:211], v[44:47]
    v_exp_f32_e64 v181, v181
    v_mfma_f32_16x16x32_bf16 v[40:43], v[156:159], v[204:207], v[40:43]
    v_exp_f32_e64 v184, v184
    v_mfma_f32_16x16x32_bf16 v[36:39], v[156:159], v[200:203], v[36:39]
    s_waitcnt lgkmcnt(0)
    v_exp_f32 v185, v185
    v_mfma_f32_16x16x32_bf16 v[48:51], v[160:163], v[200:203], v[48:51]
    v_exp_f32_e64 v178, v178
    v_mfma_f32_16x16x32_bf16 v[52:55], v[160:163], v[204:207], v[52:55]
    v_exp_f32_e64 v179, v179
    v_mfma_f32_16x16x32_bf16 v[56:59], v[160:163], v[208:211], v[56:59]
    v_exp_f32_e64 v182, v182
    v_mfma_f32_16x16x32_bf16 v[68:71], v[164:167], v[208:211], v[68:71]
    v_exp_f32_e64 v183, v183
    v_mfma_f32_16x16x32_bf16 v[64:67], v[164:167], v[204:207], v[64:67]
    v_exp_f32_e64 v186, v186
    v_mfma_f32_16x16x32_bf16 v[60:63], v[164:167], v[200:203], v[60:63]
    v_exp_f32_e64 v187, v187
    v_mfma_f32_16x16x32_bf16 v[72:75], v[168:171], v[200:203], v[72:75]
    v_exp_f32_e64 v188, v188
    v_mfma_f32_16x16x32_bf16 v[76:79], v[168:171], v[204:207], v[76:79]
    v_exp_f32_e64 v189, v189
    v_mfma_f32_16x16x32_bf16 v[80:83], v[168:171], v[208:211], v[80:83]
    v_exp_f32_e64 v192, v192
    v_mfma_f32_16x16x32_bf16 v[92:95], v[172:175], v[208:211], v[92:95]
    v_exp_f32_e64 v193, v193
    v_mfma_f32_16x16x32_bf16 v[88:91], v[172:175], v[204:207], v[88:91]
    v_exp_f32_e64 v196, v196
    v_mfma_f32_16x16x32_bf16 v[84:87], v[172:175], v[200:203], v[84:87]
    v_exp_f32 v197, v197
L_back_1:
    s_barrier
    ds_read_b128 v[144:147], v244 offset:0
    ds_read_b128 v[148:151], v245 offset:0
    ds_read_b128 v[152:155], v246 offset:0
    ds_read_b128 v[156:159], v247 offset:0
    ds_read_b128 v[160:163], v244 offset:4096
    ds_read_b128 v[164:167], v245 offset:4096
    ds_read_b128 v[168:171], v246 offset:4096
    ds_read_b128 v[172:175], v247 offset:4096
    v_pk_add_f32 v[224:225], v[224:225], v[176:177]
    v_pk_add_f32 v[226:227], v[226:227], v[180:181]
    v_pk_add_f32 v[228:229], v[228:229], v[184:185]
    v_pk_add_f32 v[224:225], v[224:225], v[178:179]
    v_pk_add_f32 v[226:227], v[226:227], v[182:183]
    v_pk_add_f32 v[228:229], v[228:229], v[186:187]
    v_pk_add_f32 v[224:225], v[224:225], v[188:189]
    v_pk_add_f32 v[226:227], v[226:227], v[192:193]
    v_pk_add_f32 v[228:229], v[228:229], v[196:197]
    v_cvt_pk_bf16_f32 v200, v176, v177
    v_cvt_pk_bf16_f32 v204, v180, v181
    v_cvt_pk_bf16_f32 v208, v184, v185
    v_cvt_pk_bf16_f32 v201, v178, v179
    v_cvt_pk_bf16_f32 v205, v182, v183
    v_cvt_pk_bf16_f32 v209, v186, v187
    v_cvt_pk_bf16_f32 v202, v188, v189
    v_cvt_pk_bf16_f32 v206, v192, v193
    v_cvt_pk_bf16_f32 v210, v196, v197
    s_waitcnt lgkmcnt(6)
    v_mfma_f32_16x16x32_bf16 v[176:179], v[144:147], v[96:99], v[212:215]
    v_exp_f32 v190, v190
    v_mfma_f32_16x16x32_bf16 v[180:183], v[144:147], v[100:103], v[216:219]
    v_exp_f32_e64 v191, v191
    v_mfma_f32_16x16x32_bf16 v[184:187], v[144:147], v[104:107], v[220:223]
    v_exp_f32_e64 v194, v194
    v_mfma_f32_16x16x32_bf16 v[176:179], v[148:151], v[108:111], v[176:179]
    v_exp_f32_e64 v195, v195
    v_mfma_f32_16x16x32_bf16 v[180:183], v[148:151], v[112:115], v[180:183]
    v_exp_f32_e64 v198, v198
    v_mfma_f32_16x16x32_bf16 v[184:187], v[148:151], v[116:119], v[184:187]
    s_waitcnt lgkmcnt(0)
    v_exp_f32 v199, v199
    v_mfma_f32_16x16x32_bf16 v[176:179], v[152:155], v[120:123], v[176:179]
    v_add_f32 v224, v224, v190
    v_add_f32 v225, v225, v191
    v_mfma_f32_16x16x32_bf16 v[180:183], v[152:155], v[124:127], v[180:183]
    v_add_f32 v226, v226, v194
    v_add_f32 v227, v227, v195
    v_mfma_f32_16x16x32_bf16 v[184:187], v[152:155], v[128:131], v[184:187]
    ds_read_b64_tr_b16 v[144:145], v248 offset:32768
    v_add_f32_e64 v228, v228, v198
    v_mfma_f32_16x16x32_bf16 v[176:179], v[156:159], v[132:135], v[176:179]
    ds_read_b64_tr_b16 v[146:147], v248 offset:36864
    v_add_f32_e64 v229, v229, v199
    v_mfma_f32_16x16x32_bf16 v[180:183], v[156:159], v[136:139], v[180:183]
    ds_read_b64_tr_b16 v[148:149], v249 offset:32768
    v_cvt_pk_bf16_f32 v203, v190, v191
    v_mfma_f32_16x16x32_bf16 v[184:187], v[156:159], v[140:143], v[184:187]
    ds_read_b64_tr_b16 v[150:151], v249 offset:36864
    v_cvt_pk_bf16_f32 v207, v194, v195
    v_cvt_pk_bf16_f32 v211, v198, v199
    v_mfma_f32_16x16x32_bf16 v[188:191], v[160:163], v[96:99], v[212:215]
    s_sub_u32 s64, s64, 1
    ds_read_b64_tr_b16 v[152:153], v250 offset:32768
    v_mfma_f32_16x16x32_bf16 v[192:195], v[160:163], v[100:103], v[216:219]
    ds_read_b64_tr_b16 v[154:155], v250 offset:36864
    v_mfma_f32_16x16x32_bf16 v[196:199], v[160:163], v[104:107], v[220:223]
    ds_read_b64_tr_b16 v[156:157], v251 offset:32768
    v_mfma_f32_16x16x32_bf16 v[188:191], v[164:167], v[108:111], v[188:191]
    ds_read_b64_tr_b16 v[158:159], v251 offset:36864
    v_mfma_f32_16x16x32_bf16 v[192:195], v[164:167], v[112:115], v[192:195]
    ds_read_b64_tr_b16 v[160:161], v252 offset:32768
    v_max3_f32 v230, v176, v177, v178
    v_mfma_f32_16x16x32_bf16 v[196:199], v[164:167], v[116:119], v[196:199]
    ds_read_b64_tr_b16 v[162:163], v252 offset:36864
    v_max3_f32 v230, v179, v180, v230
    v_mfma_f32_16x16x32_bf16 v[188:191], v[168:171], v[120:123], v[188:191]
    ds_read_b64_tr_b16 v[164:165], v253 offset:32768
    v_max3_f32 v230, v181, v182, v230
    v_mfma_f32_16x16x32_bf16 v[192:195], v[168:171], v[124:127], v[192:195]
    ds_read_b64_tr_b16 v[166:167], v253 offset:36864
    v_max3_f32 v230, v183, v184, v230
    v_mfma_f32_16x16x32_bf16 v[196:199], v[168:171], v[128:131], v[196:199]
    ds_read_b64_tr_b16 v[168:169], v254 offset:32768
    v_max3_f32 v230, v185, v186, v230
    v_mfma_f32_16x16x32_bf16 v[188:191], v[172:175], v[132:135], v[188:191]
    ds_read_b64_tr_b16 v[170:171], v254 offset:36864
    v_max_f32 v230, v187, v230
    v_mfma_f32_16x16x32_bf16 v[192:195], v[172:175], v[136:139], v[192:195]
    s_waitcnt lgkmcnt(4)
    v_mfma_f32_16x16x32_bf16 v[196:199], v[172:175], v[140:143], v[196:199]
    ds_read_b64_tr_b16 v[172:173], v255 offset:32768
    v_mfma_f32_16x16x32_bf16 v[0:3], v[144:147], v[200:203], v[0:3]
    ds_read_b64_tr_b16 v[174:175], v255 offset:36864
    v_mfma_f32_16x16x32_bf16 v[4:7], v[144:147], v[204:207], v[4:7]
    v_max3_f32 v230, v188, v189, v230
    v_max3_f32 v230, v190, v191, v230
    v_mfma_f32_16x16x32_bf16 v[8:11], v[144:147], v[208:211], v[8:11]
    v_max3_f32 v230, v192, v193, v230
    v_max3_f32 v230, v194, v195, v230
    v_mfma_f32_16x16x32_bf16 v[20:23], v[148:151], v[208:211], v[20:23]
    v_max3_f32 v230, v196, v197, v230
    v_max3_f32 v230, v198, v199, v230
    v_mfma_f32_16x16x32_bf16 v[16:19], v[148:151], v[204:207], v[16:19]
    v_cmp_lt_f32 vcc, s66, v230
    v_mfma_f32_16x16x32_bf16 v[12:15], v[148:151], v[200:203], v[12:15]
    s_cbranch_vccnz L_up_2
    v_mfma_f32_16x16x32_bf16 v[24:27], v[152:155], v[200:203], v[24:27]
    v_exp_f32 v176, v176
    v_mfma_f32_16x16x32_bf16 v[28:31], v[152:155], v[204:207], v[28:31]
    v_exp_f32_e64 v177, v177
    v_mfma_f32_16x16x32_bf16 v[32:35], v[152:155], v[208:211], v[32:35]
    v_exp_f32_e64 v180, v180
    v_mfma_f32_16x16x32_bf16 v[44:47], v[156:159], v[208:211], v[44:47]
    v_exp_f32_e64 v181, v181
    v_mfma_f32_16x16x32_bf16 v[40:43], v[156:159], v[204:207], v[40:43]
    v_exp_f32_e64 v184, v184
    v_mfma_f32_16x16x32_bf16 v[36:39], v[156:159], v[200:203], v[36:39]
    s_waitcnt lgkmcnt(0)
    v_exp_f32 v185, v185
    v_mfma_f32_16x16x32_bf16 v[48:51], v[160:163], v[200:203], v[48:51]
    v_exp_f32_e64 v178, v178
    v_mfma_f32_16x16x32_bf16 v[52:55], v[160:163], v[204:207], v[52:55]
    v_exp_f32_e64 v179, v179
    v_mfma_f32_16x16x32_bf16 v[56:59], v[160:163], v[208:211], v[56:59]
    v_exp_f32_e64 v182, v182
    v_mfma_f32_16x16x32_bf16 v[68:71], v[164:167], v[208:211], v[68:71]
    v_exp_f32_e64 v183, v183
    v_mfma_f32_16x16x32_bf16 v[64:67], v[164:167], v[204:207], v[64:67]
    s_cmp_lg_u32 s64, 0
    v_exp_f32 v186, v186
    v_mfma_f32_16x16x32_bf16 v[60:63], v[164:167], v[200:203], v[60:63]
    v_exp_f32_e64 v187, v187
    v_mfma_f32_16x16x32_bf16 v[72:75], v[168:171], v[200:203], v[72:75]
    v_exp_f32_e64 v188, v188
    v_mfma_f32_16x16x32_bf16 v[76:79], v[168:171], v[204:207], v[76:79]
    v_exp_f32_e64 v189, v189
    v_mfma_f32_16x16x32_bf16 v[80:83], v[168:171], v[208:211], v[80:83]
    v_exp_f32_e64 v192, v192
    v_mfma_f32_16x16x32_bf16 v[92:95], v[172:175], v[208:211], v[92:95]
    v_exp_f32_e64 v193, v193
    v_mfma_f32_16x16x32_bf16 v[88:91], v[172:175], v[204:207], v[88:91]
    v_exp_f32_e64 v196, v196
    v_mfma_f32_16x16x32_bf16 v[84:87], v[172:175], v[200:203], v[84:87]
    v_exp_f32 v197, v197
L_back_2:
    s_cbranch_scc1 L_aloop
    v_exp_f32 v190, v190
    v_exp_f32 v191, v191
    v_exp_f32 v194, v194
    v_exp_f32 v195, v195
    v_exp_f32 v198, v198
    v_exp_f32 v199, v199
    v_pk_add_f32 v[224:225], v[224:225], v[176:177]
    v_pk_add_f32 v[226:227], v[226:227], v[180:181]
    v_pk_add_f32 v[228:229], v[228:229], v[184:185]
    v_pk_add_f32 v[224:225], v[224:225], v[178:179]
    v_pk_add_f32 v[226:227], v[226:227], v[182:183]
    v_pk_add_f32 v[228:229], v[228:229], v[186:187]
    v_pk_add_f32 v[224:225], v[224:225], v[188:189]
    v_pk_add_f32 v[226:227], v[226:227], v[192:193]
    v_pk_add_f32 v[228:229], v[228:229], v[196:197]
    v_pk_add_f32 v[224:225], v[224:225], v[190:191]
    v_pk_add_f32 v[226:227], v[226:227], v[194:195]
    v_pk_add_f32 v[228:229], v[228:229], v[198:199]
    v_add_f32 v224, v224, v225
    v_add_f32 v226, v226, v227
    v_add_f32 v228, v228, v229
    v_mov_b32 v235, v224
    v_mov_b32 v236, v226
    v_mov_b32 v237, v228
    v_permlane32_swap_b32 v224, v235
    v_permlane32_swap_b32 v226, v236
    v_permlane32_swap_b32 v228, v237
    v_add_f32 v224, v224, v235
    v_add_f32 v226, v226, v236
    v_add_f32 v228, v228, v237
    v_mov_b32 v235, v224
    v_mov_b32 v236, v226
    v_mov_b32 v237, v228
    v_permlane16_swap_b32 v224, v235
    v_permlane16_swap_b32 v226, v236
    v_permlane16_swap_b32 v228, v237
    v_add_f32 v224, v224, v235
    v_add_f32 v226, v226, v236
    v_add_f32 v228, v228, v237
    v_rcp_f32 v224, v224
    v_rcp_f32 v226, v226
    v_rcp_f32 v228, v228
    v_pk_mul_f32 v[176:177], v[176:177], v[224:225] op_sel_hi:[1,0]
    v_pk_mul_f32 v[178:179], v[178:179], v[224:225] op_sel_hi:[1,0]
    v_pk_mul_f32 v[180:181], v[180:181], v[226:227] op_sel_hi:[1,0]
    v_pk_mul_f32 v[182:183], v[182:183], v[226:227] op_sel_hi:[1,0]
    v_pk_mul_f32 v[184:185], v[184:185], v[228:229] op_sel_hi:[1,0]
    v_pk_mul_f32 v[186:187], v[186:187], v[228:229] op_sel_hi:[1,0]
    v_pk_mul_f32 v[188:189], v[188:189], v[224:225] op_sel_hi:[1,0]
    v_pk_mul_f32 v[190:191], v[190:191], v[224:225] op_sel_hi:[1,0]
    v_pk_mul_f32 v[192:193], v[192:193], v[226:227] op_sel_hi:[1,0]
    v_pk_mul_f32 v[194:195], v[194:195], v[226:227] op_sel_hi:[1,0]
    v_pk_mul_f32 v[196:197], v[196:197], v[228:229] op_sel_hi:[1,0]
    v_pk_mul_f32 v[198:199], v[198:199], v[228:229] op_sel_hi:[1,0]
    v_cvt_pk_bf16_f32 v200, v176, v177
    v_cvt_pk_bf16_f32 v204, v180, v181
    v_cvt_pk_bf16_f32 v208, v184, v185
    v_cvt_pk_bf16_f32 v201, v178, v179
    v_cvt_pk_bf16_f32 v205, v182, v183
    v_cvt_pk_bf16_f32 v209, v186, v187
    v_cvt_pk_bf16_f32 v202, v188, v189
    v_cvt_pk_bf16_f32 v206, v192, v193
    v_cvt_pk_bf16_f32 v210, v196, v197
    v_cvt_pk_bf16_f32 v203, v190, v191
    v_cvt_pk_bf16_f32 v207, v194, v195
    v_cvt_pk_bf16_f32 v211, v198, v199
    v_pk_mul_f32 v[0:1], v[0:1], v[224:225] op_sel_hi:[1,0]
    v_pk_mul_f32 v[2:3], v[2:3], v[224:225] op_sel_hi:[1,0]
    v_pk_mul_f32 v[4:5], v[4:5], v[226:227] op_sel_hi:[1,0]
    v_pk_mul_f32 v[6:7], v[6:7], v[226:227] op_sel_hi:[1,0]
    v_pk_mul_f32 v[8:9], v[8:9], v[228:229] op_sel_hi:[1,0]
    v_pk_mul_f32 v[10:11], v[10:11], v[228:229] op_sel_hi:[1,0]
    v_pk_mul_f32 v[12:13], v[12:13], v[224:225] op_sel_hi:[1,0]
    v_pk_mul_f32 v[14:15], v[14:15], v[224:225] op_sel_hi:[1,0]
    v_pk_mul_f32 v[16:17], v[16:17], v[226:227] op_sel_hi:[1,0]
    v_pk_mul_f32 v[18:19], v[18:19], v[226:227] op_sel_hi:[1,0]
    v_pk_mul_f32 v[20:21], v[20:21], v[228:229] op_sel_hi:[1,0]
    v_pk_mul_f32 v[22:23], v[22:23], v[228:229] op_sel_hi:[1,0]
    v_pk_mul_f32 v[24:25], v[24:25], v[224:225] op_sel_hi:[1,0]
    v_pk_mul_f32 v[26:27], v[26:27], v[224:225] op_sel_hi:[1,0]
    v_pk_mul_f32 v[28:29], v[28:29], v[226:227] op_sel_hi:[1,0]
    v_pk_mul_f32 v[30:31], v[30:31], v[226:227] op_sel_hi:[1,0]
    v_pk_mul_f32 v[32:33], v[32:33], v[228:229] op_sel_hi:[1,0]
    v_pk_mul_f32 v[34:35], v[34:35], v[228:229] op_sel_hi:[1,0]
    v_pk_mul_f32 v[36:37], v[36:37], v[224:225] op_sel_hi:[1,0]
    v_pk_mul_f32 v[38:39], v[38:39], v[224:225] op_sel_hi:[1,0]
    v_pk_mul_f32 v[40:41], v[40:41], v[226:227] op_sel_hi:[1,0]
    v_pk_mul_f32 v[42:43], v[42:43], v[226:227] op_sel_hi:[1,0]
    v_pk_mul_f32 v[44:45], v[44:45], v[228:229] op_sel_hi:[1,0]
    v_pk_mul_f32 v[46:47], v[46:47], v[228:229] op_sel_hi:[1,0]
    s_barrier
    ds_read_b64_tr_b16 v[144:145], v248 offset:0
    ds_read_b64_tr_b16 v[146:147], v248 offset:4096
    ds_read_b64_tr_b16 v[148:149], v249 offset:0
    ds_read_b64_tr_b16 v[150:151], v249 offset:4096
    ds_read_b64_tr_b16 v[152:153], v250 offset:0
    ds_read_b64_tr_b16 v[154:155], v250 offset:4096
    ds_read_b64_tr_b16 v[156:157], v251 offset:0
    ds_read_b64_tr_b16 v[158:159], v251 offset:4096
    ds_read_b64_tr_b16 v[160:161], v252 offset:0
    ds_read_b64_tr_b16 v[162:163], v252 offset:4096
    ds_read_b64_tr_b16 v[164:165], v253 offset:0
    ds_read_b64_tr_b16 v[166:167], v253 offset:4096
    ds_read_b64_tr_b16 v[168:169], v254 offset:0
    ds_read_b64_tr_b16 v[170:171], v254 offset:4096
    ds_read_b64_tr_b16 v[172:173], v255 offset:0
    ds_read_b64_tr_b16 v[174:175], v255 offset:4096
    s_nop 0
    v_pk_mul_f32 v[48:49], v[48:49], v[224:225] op_sel_hi:[1,0]
    v_pk_mul_f32 v[50:51], v[50:51], v[224:225] op_sel_hi:[1,0]
    v_pk_mul_f32 v[52:53], v[52:53], v[226:227] op_sel_hi:[1,0]
    v_pk_mul_f32 v[54:55], v[54:55], v[226:227] op_sel_hi:[1,0]
    v_pk_mul_f32 v[56:57], v[56:57], v[228:229] op_sel_hi:[1,0]
    v_pk_mul_f32 v[58:59], v[58:59], v[228:229] op_sel_hi:[1,0]
    v_pk_mul_f32 v[60:61], v[60:61], v[224:225] op_sel_hi:[1,0]
    v_pk_mul_f32 v[62:63], v[62:63], v[224:225] op_sel_hi:[1,0]
    v_pk_mul_f32 v[64:65], v[64:65], v[226:227] op_sel_hi:[1,0]
    v_pk_mul_f32 v[66:67], v[66:67], v[226:227] op_sel_hi:[1,0]
    v_pk_mul_f32 v[68:69], v[68:69], v[228:229] op_sel_hi:[1,0]
    v_pk_mul_f32 v[70:71], v[70:71], v[228:229] op_sel_hi:[1,0]
    v_pk_mul_f32 v[72:73], v[72:73], v[224:225] op_sel_hi:[1,0]
    v_pk_mul_f32 v[74:75], v[74:75], v[224:225] op_sel_hi:[1,0]
    v_pk_mul_f32 v[76:77], v[76:77], v[226:227] op_sel_hi:[1,0]
    v_pk_mul_f32 v[78:79], v[78:79], v[226:227] op_sel_hi:[1,0]
    v_pk_mul_f32 v[80:81], v[80:81], v[228:229] op_sel_hi:[1,0]
    v_pk_mul_f32 v[82:83], v[82:83], v[228:229] op_sel_hi:[1,0]
    v_pk_mul_f32 v[84:85], v[84:85], v[224:225] op_sel_hi:[1,0]
    v_pk_mul_f32 v[86:87], v[86:87], v[224:225] op_sel_hi:[1,0]
    v_pk_mul_f32 v[88:89], v[88:89], v[226:227] op_sel_hi:[1,0]
    v_pk_mul_f32 v[90:91], v[90:91], v[226:227] op_sel_hi:[1,0]
    v_pk_mul_f32 v[92:93], v[92:93], v[228:229] op_sel_hi:[1,0]
    v_pk_mul_f32 v[94:95], v[94:95], v[228:229] op_sel_hi:[1,0]
    s_cmp_lg_u32 s74, 1
    s_cbranch_scc1 L_far
    s_waitcnt lgkmcnt(12)
    v_mfma_f32_16x16x32_bf16 v[0:3], v[144:147], v[200:203], v[0:3]
    v_mfma_f32_16x16x32_bf16 v[4:7], v[144:147], v[204:207], v[4:7]
    v_mfma_f32_16x16x32_bf16 v[8:11], v[144:147], v[208:211], v[8:11]
    v_mfma_f32_16x16x32_bf16 v[20:23], v[148:151], v[208:211], v[20:23]
    v_mfma_f32_16x16x32_bf16 v[16:19], v[148:151], v[204:207], v[16:19]
    v_mfma_f32_16x16x32_bf16 v[12:15], v[148:151], v[200:203], v[12:15]
    s_waitcnt lgkmcnt(10)
    v_mfma_f32_16x16x32_bf16 v[24:27], v[152:155], v[200:203], v[24:27]
    s_nop 0
    v_cvt_pk_bf16_f32 v96, v0, v1
    v_cvt_pk_bf16_f32 v97, v2, v3
    v_mfma_f32_16x16x32_bf16 v[28:31], v[152:155], v[204:207], v[28:31]
    v_cvt_pk_bf16_f32 v100, v4, v5
    v_cvt_pk_bf16_f32 v101, v6, v7
    v_mfma_f32_16x16x32_bf16 v[32:35], v[152:155], v[208:211], v[32:35]
    v_cvt_pk_bf16_f32 v104, v8, v9
    v_cvt_pk_bf16_f32 v105, v10, v11
    s_waitcnt lgkmcnt(8)
    v_mfma_f32_16x16x32_bf16 v[44:47], v[156:159], v[208:211], v[44:47]
    v_cvt_pk_bf16_f32 v98, v12, v13
    v_cvt_pk_bf16_f32 v99, v14, v15
    v_mfma_f32_16x16x32_bf16 v[40:43], v[156:159], v[204:207], v[40:43]
    v_cvt_pk_bf16_f32 v102, v16, v17
    v_cvt_pk_bf16_f32 v103, v18, v19
    v_mfma_f32_16x16x32_bf16 v[36:39], v[156:159], v[200:203], v[36:39]
    v_cvt_pk_bf16_f32 v106, v20, v21
    v_cvt_pk_bf16_f32 v107, v22, v23
    s_waitcnt lgkmcnt(6)
    v_mfma_f32_16x16x32_bf16 v[48:51], v[160:163], v[200:203], v[48:51]
    s_mov_b32 s60, 0
    buffer_store_dwordx4 v[96:99], v241, s[44:47], s60 offen offset:0
    buffer_store_dwordx4 v[100:103], v241, s[44:47], s60 offen offset:1024
    buffer_store_dwordx4 v[104:107], v241, s[44:47], s60 offen offset:2048
    v_cvt_pk_bf16_f32 v108, v24, v25
    v_cvt_pk_bf16_f32 v109, v26, v27
    v_mfma_f32_16x16x32_bf16 v[52:55], v[160:163], v[204:207], v[52:55]
    v_cvt_pk_bf16_f32 v112, v28, v29
    v_cvt_pk_bf16_f32 v113, v30, v31
    v_mfma_f32_16x16x32_bf16 v[56:59], v[160:163], v[208:211], v[56:59]
    v_cvt_pk_bf16_f32 v116, v32, v33
    v_cvt_pk_bf16_f32 v117, v34, v35
    s_waitcnt lgkmcnt(4)
    v_mfma_f32_16x16x32_bf16 v[68:71], v[164:167], v[208:211], v[68:71]
    v_cvt_pk_bf16_f32 v110, v36, v37
    v_cvt_pk_bf16_f32 v111, v38, v39
    v_mfma_f32_16x16x32_bf16 v[64:67], v[164:167], v[204:207], v[64:67]
    v_cvt_pk_bf16_f32 v114, v40, v41
    v_cvt_pk_bf16_f32 v115, v42, v43
    v_mfma_f32_16x16x32_bf16 v[60:63], v[164:167], v[200:203], v[60:63]
    v_cvt_pk_bf16_f32 v118, v44, v45
    v_cvt_pk_bf16_f32 v119, v46, v47
    s_waitcnt lgkmcnt(2)
    v_mfma_f32_16x16x32_bf16 v[72:75], v[168:171], v[200:203], v[72:75]
    s_mov_b32 s60, 3072
    buffer_store_dwordx4 v[108:111], v241, s[44:47], s60 offen offset:0
    buffer_store_dwordx4 v[112:115], v241, s[44:47], s60 offen offset:1024
    buffer_store_dwordx4 v[116:119], v241, s[44:47], s60 offen offset:2048
    v_cvt_pk_bf16_f32 v120, v48, v49
    v_cvt_pk_bf16_f32 v121, v50, v51
    v_mfma_f32_16x16x32_bf16 v[76:79], v[168:171], v[204:207], v[76:79]
    v_cvt_pk_bf16_f32 v124, v52, v53
    v_cvt_pk_bf16_f32 v125, v54, v55
    v_mfma_f32_16x16x32_bf16 v[80:83], v[168:171], v[208:211], v[80:83]
    v_cvt_pk_bf16_f32 v128, v56, v57
    v_cvt_pk_bf16_f32 v129, v58, v59
    s_waitcnt lgkmcnt(0)
    v_mfma_f32_16x16x32_bf16 v[92:95], v[172:175], v[208:211], v[92:95]
    v_cvt_pk_bf16_f32 v122, v60, v61
    v_cvt_pk_bf16_f32 v123, v62, v63
    v_mfma_f32_16x16x32_bf16 v[88:91], v[172:175], v[204:207], v[88:91]
    v_cvt_pk_bf16_f32 v126, v64, v65
    v_cvt_pk_bf16_f32 v127, v66, v67
    v_mfma_f32_16x16x32_bf16 v[84:87], v[172:175], v[200:203], v[84:87]
    v_cvt_pk_bf16_f32 v130, v68, v69
    v_cvt_pk_bf16_f32 v131, v70, v71
    s_mov_b32 s60, 24576
    buffer_store_dwordx4 v[120:123], v241, s[44:47], s60 offen offset:0
    buffer_store_dwordx4 v[124:127], v241, s[44:47], s60 offen offset:1024
    buffer_store_dwordx4 v[128:131], v241, s[44:47], s60 offen offset:2048
    s_nop 0
    v_cvt_pk_bf16_f32 v132, v72, v73
    v_cvt_pk_bf16_f32 v133, v74, v75
    v_cvt_pk_bf16_f32 v136, v76, v77
    v_cvt_pk_bf16_f32 v137, v78, v79
    v_cvt_pk_bf16_f32 v140, v80, v81
    v_cvt_pk_bf16_f32 v141, v82, v83
    v_cvt_pk_bf16_f32 v134, v84, v85
    v_cvt_pk_bf16_f32 v135, v86, v87
    v_cvt_pk_bf16_f32 v138, v88, v89
    v_cvt_pk_bf16_f32 v139, v90, v91
    v_cvt_pk_bf16_f32 v142, v92, v93
    v_cvt_pk_bf16_f32 v143, v94, v95
    s_mov_b32 s60, 27648
    buffer_store_dwordx4 v[132:135], v241, s[44:47], s60 offen offset:0
    buffer_store_dwordx4 v[136:139], v241, s[44:47], s60 offen offset:1024
    buffer_store_dwordx4 v[140:143], v241, s[44:47], s60 offen offset:2048
L_near:
    s_lshl_b32 s60, s53, 6
    v_and_b32 v232, 0xfff, v248
    v_xor_b32 v232, s60, v232
    v_xor_b32 v233, 32, v232
    v_xor_b32 v234, 64, v232
    v_xor_b32 v235, 96, v232
    v_xor_b32 v236, 128, v232
    v_xor_b32 v237, 160, v232
    v_xor_b32 v238, 192, v232
    v_xor_b32 v239, 224, v232
    s_add_u32 s60, s69, 65536
    v_lshl_add_u32 v240, v243, 4, s60
    v_mov_b32 v245, 1
    s_barrier
    ds_read_b64_tr_b16 v[144:145], v232 offset:0
    ds_read_b64_tr_b16 v[146:147], v232 offset:4096
    ds_read_b64_tr_b16 v[148:149], v233 offset:0
    ds_read_b64_tr_b16 v[150:151], v233 offset:4096
    ds_read_b64_tr_b16 v[152:153], v234 offset:0
    ds_read_b64_tr_b16 v[154:155], v234 offset:4096
    ds_read_b64_tr_b16 v[156:157], v235 offset:0
    ds_read_b64_tr_b16 v[158:159], v235 offset:4096
    ds_read_b64_tr_b16 v[160:161], v236 offset:0
    ds_read_b64_tr_b16 v[162:163], v236 offset:4096
    ds_read_b64_tr_b16 v[164:165], v237 offset:0
    ds_read_b64_tr_b16 v[166:167], v237 offset:4096
    ds_read_b64_tr_b16 v[168:169], v238 offset:0
    ds_read_b64_tr_b16 v[170:171], v238 offset:4096
    ds_read_b64_tr_b16 v[172:173], v239 offset:0
    ds_read_b64_tr_b16 v[174:175], v239 offset:4096
    s_mul_i32 s60, s76, 393216
    s_add_u32 s60, s60, s69
    v_lshl_add_u32 v240, v243, 4, s60
    v_add_u32 v251, 3072, v240
    s_mov_b32 s92, 1658412164
    s_mov_b32 s93, 16479210
    s_lshl_b32 s72, s54, 1
    s_mov_b32 s68, 0
    s_waitcnt lgkmcnt(12)
    v_mfma_f32_16x16x32_bf16 v[0:3], v[144:147], v[96:99], 0
    ds_read_b64_tr_b16 v[188:189], v232 offset:8192
    s_add_u32 s68, s68, 1
    v_mfma_f32_16x16x32_bf16 v[4:7], v[144:147], v[100:103], 0
    ds_read_b64_tr_b16 v[190:191], v232 offset:12288
    s_and_b32 s68, s68, 3
    v_mfma_f32_16x16x32_bf16 v[8:11], v[144:147], v[104:107], 0
    ds_read_b64_tr_b16 v[192:193], v233 offset:8192
    s_cselect_b32 s65, 16384, s62
    v_mfma_f32_16x16x32_bf16 v[20:23], v[148:151], v[104:107], 0
    ds_read_b64_tr_b16 v[194:195], v233 offset:12288
    v_mfma_f32_16x16x32_bf16 v[16:19], v[148:151], v[100:103], 0
    ds_read_b64_tr_b16 v[196:197], v234 offset:8192
    v_mfma_f32_16x16x32_bf16 v[12:15], v[148:151], v[96:99], 0
    ds_read_b64_tr_b16 v[198:199], v234 offset:12288
    s_waitcnt lgkmcnt(12)
    v_mfma_f32_16x16x32_bf16 v[24:27], v[152:155], v[96:99], 0
    ds_read_b64_tr_b16 v[200:201], v235 offset:8192
    v_mfma_f32_16x16x32_bf16 v[28:31], v[152:155], v[100:103], 0
    ds_read_b64_tr_b16 v[202:203], v235 offset:12288
    v_mfma_f32_16x16x32_bf16 v[32:35], v[152:155], v[104:107], 0
    ds_read_b64_tr_b16 v[204:205], v236 offset:8192
    v_add_u32 v232, s65, v232
    v_mfma_f32_16x16x32_bf16 v[44:47], v[156:159], v[104:107], 0
    ds_read_b64_tr_b16 v[206:207], v236 offset:12288
    v_add_u32_e64 v233, s65, v233
    v_mfma_f32_16x16x32_bf16 v[40:43], v[156:159], v[100:103], 0
    ds_read_b64_tr_b16 v[208:209], v237 offset:8192
    v_add_u32_e64 v234, s65, v234
    v_mfma_f32_16x16x32_bf16 v[36:39], v[156:159], v[96:99], 0
    ds_read_b64_tr_b16 v[210:211], v237 offset:12288
    v_add_u32_e64 v235, s65, v235
    v_mfma_f32_16x16x32_bf16 v[48:51], v[160:163], v[96:99], 0
    ds_read_b64_tr_b16 v[212:213], v238 offset:8192
    v_add_u32_e64 v236, s65, v236
    v_mfma_f32_16x16x32_bf16 v[52:55], v[160:163], v[100:103], 0
    ds_read_b64_tr_b16 v[214:215], v238 offset:12288
    v_add_u32_e64 v237, s65, v237
    v_mfma_f32_16x16x32_bf16 v[56:59], v[160:163], v[104:107], 0
    ds_read_b64_tr_b16 v[216:217], v239 offset:8192
    v_add_u32 v238, s65, v238
    s_waitcnt lgkmcnt(12)
    v_mfma_f32_16x16x32_bf16 v[68:71], v[164:167], v[104:107], 0
    ds_read_b64_tr_b16 v[218:219], v239 offset:12288
    v_mfma_f32_16x16x32_bf16 v[64:67], v[164:167], v[100:103], 0
    v_add_u32_e64 v239, s65, v239
    v_mfma_f32_16x16x32_bf16 v[60:63], v[164:167], v[96:99], 0
    v_mfma_f32_16x16x32_bf16 v[72:75], v[168:171], v[96:99], 0
    v_mfma_f32_16x16x32_bf16 v[76:79], v[168:171], v[100:103], 0
    v_mfma_f32_16x16x32_bf16 v[80:83], v[168:171], v[104:107], 0
    v_mfma_f32_16x16x32_bf16 v[92:95], v[172:175], v[104:107], 0
    v_mfma_f32_16x16x32_bf16 v[88:91], v[172:175], v[100:103], 0
    s_waitcnt lgkmcnt(0)
    v_mfma_f32_16x16x32_bf16 v[84:87], v[172:175], v[96:99], 0
    s_cmp_eq_u32 s74, 0
    s_mov_b64 exec, 0xff
    s_waitcnt vmcnt(0)
    s_cbranch_scc1 L_farflag
    buffer_store_dword v242, v231, s[44:47], 0 offen
L_flagged:
    s_mov_b64 exec, -1
    ds_read_b64_tr_b16 v[144:145], v232 offset:0
    v_mfma_f32_16x16x32_bf16 v[0:3], v[188:191], v[108:111], v[0:3]
    ds_read_b64_tr_b16 v[146:147], v232 offset:4096
    s_mul_i32 s60, s57, 9216
    s_add_u32 s60, s60, 16777216
    v_mfma_f32_16x16x32_bf16 v[4:7], v[188:191], v[112:115], v[4:7]
    ds_read_b64_tr_b16 v[148:149], v233 offset:0
    v_lshl_add_u32 v241, v243, 4, s60
    v_and_b32 v247, 3, v243
    v_mfma_f32_16x16x32_bf16 v[8:11], v[188:191], v[116:119], v[8:11]
    ds_read_b64_tr_b16 v[150:151], v233 offset:4096
    s_lshl_b32 s60, s57, 9
    v_mfma_f32_16x16x32_bf16 v[20:23], v[192:195], v[116:119], v[20:23]
    ds_read_b64_tr_b16 v[152:153], v234 offset:0
    s_add_u32 s60, s60, 50331648
    v_lshl_add_u32 v246, v247, 7, s60
    v_mfma_f32_16x16x32_bf16 v[16:19], v[192:195], v[112:115], v[16:19]
    ds_read_b64_tr_b16 v[154:155], v234 offset:4096
    v_xor_b32 v244, s2, v247
    v_mfma_f32_16x16x32_bf16 v[12:15], v[192:195], v[108:111], v[12:15]
    ds_read_b64_tr_b16 v[156:157], v235 offset:0
    v_lshl_add_u32 v244, v244, 11, v246
    v_max_u32_e64 v247, 1, v247
    v_mfma_f32_16x16x32_bf16 v[24:27], v[196:199], v[108:111], v[24:27]
    ds_read_b64_tr_b16 v[158:159], v235 offset:4096
    s_lshl_b32 s61, s2, 11
    s_add_u32 s60, s60, s61
    v_mfma_f32_16x16x32_bf16 v[28:31], v[196:199], v[112:115], v[28:31]
    ds_read_b64_tr_b16 v[160:161], v236 offset:0
    v_lshl_add_u32 v246, v247, 7, s60
    v_mfma_f32_16x16x32_bf16 v[32:35], v[196:199], v[116:119], v[32:35]
    ds_read_b64_tr_b16 v[162:163], v236 offset:4096
    v_and_b32 v252, 12, v243
    v_lshrrev_b32 v248, 4, v243
    v_mfma_f32_16x16x32_bf16 v[44:47], v[200:203], v[116:119], v[44:47]
    ds_read_b64_tr_b16 v[164:165], v237 offset:0
    v_or_b32_e64 v252, v252, v248
    v_mfma_f32_16x16x32_bf16 v[40:43], v[200:203], v[112:115], v[40:43]
    ds_read_b64_tr_b16 v[166:167], v237 offset:4096
    v_and_b32_e64 v248, 3, v243
    v_lshl_or_b32 v252, v248, 4, v252
    v_mfma_f32_16x16x32_bf16 v[36:39], v[200:203], v[108:111], v[36:39]
    ds_read_b64_tr_b16 v[168:169], v238 offset:0
    v_and_b32_e64 v248, 15, v252
    v_bfe_u32 v249, v252, 4, 1
    v_mfma_f32_16x16x32_bf16 v[48:51], v[204:207], v[108:111], v[48:51]
    ds_read_b64_tr_b16 v[170:171], v238 offset:4096
    v_bfe_u32 v250, v252, 5, 1
    v_mfma_f32_16x16x32_bf16 v[52:55], v[204:207], v[112:115], v[52:55]
    ds_read_b64_tr_b16 v[172:173], v239 offset:0
    v_lshlrev_b32_e64 v252, 2, v252
    s_mul_i32 s60, s55, 192
    v_mfma_f32_16x16x32_bf16 v[56:59], v[204:207], v[116:119], v[56:59]
    ds_read_b64_tr_b16 v[174:175], v239 offset:4096
    s_mul_i32 s61, s57, 48
    v_mfma_f32_16x16x32_bf16 v[68:71], v[208:211], v[116:119], v[68:71]
    s_add_u32 s60, s60, s61
    s_lshl_b32 s60, s60, 12
    v_mfma_f32_16x16x32_bf16 v[64:67], v[208:211], v[112:115], v[64:67]
    s_lshl_b32 s61, s52, 11
    s_add_u32 s60, s60, s61
    v_mfma_f32_16x16x32_bf16 v[60:63], v[208:211], v[108:111], v[60:63]
    s_lshl_b32 s61, s56, 8
    v_mfma_f32_16x16x32_bf16 v[72:75], v[212:215], v[108:111], v[72:75]
    s_add_u32 s60, s60, s61
    s_lshl_b32 s61, s53, 6
    v_mfma_f32_16x16x32_bf16 v[76:79], v[212:215], v[112:115], v[76:79]
    s_add_u32 s60, s60, s61
    v_mfma_f32_16x16x32_bf16 v[80:83], v[212:215], v[116:119], v[80:83]
    v_lshl_add_u32 v248, v248, 12, s60
    v_lshl_add_u32 v248, v249, 5, v248
    v_mfma_f32_16x16x32_bf16 v[92:95], v[216:219], v[116:119], v[92:95]
    v_lshl_add_u32 v248, v250, 4, v248
    v_mfma_f32_16x16x32_bf16 v[88:91], v[216:219], v[112:115], v[88:91]
    s_waitcnt lgkmcnt(0)
    v_mfma_f32_16x16x32_bf16 v[84:87], v[216:219], v[108:111], v[84:87]
    s_barrier
    s_add_u32 s94, s92, s72
    s_and_b32 s94, s94, 15
    s_mul_i32 s94, s94, 24576
    s_lshr_b64 s[92:93], s[92:93], 4
    buffer_load_dwordx4 v[176:179], v240, s[44:47], s94 offen offset:0 sc1
    buffer_load_dwordx4 v[180:183], v240, s[44:47], s94 offen offset:1024 sc1
    buffer_load_dwordx4 v[184:187], v240, s[44:47], s94 offen offset:2048 sc1
    buffer_load_dwordx4 v[220:223], v251, s[44:47], s94 offen offset:0 sc1
    buffer_load_dwordx4 v[224:227], v251, s[44:47], s94 offen offset:1024 sc1
    buffer_load_dwordx4 v[228:231], v251, s[44:47], s94 offen offset:2048 sc1
    s_add_u32 s94, s92, s72
    s_and_b32 s94, s94, 15
    s_mul_i32 s94, s94, 24576
    s_lshr_b64 s[92:93], s[92:93], 4
    buffer_load_dwordx4 v[96:99], v240, s[44:47], s94 offen offset:0 sc1
    buffer_load_dwordx4 v[100:103], v240, s[44:47], s94 offen offset:1024 sc1
    buffer_load_dwordx4 v[104:107], v240, s[44:47], s94 offen offset:2048 sc1
    v_mfma_f32_16x16x32_bf16 v[0:3], v[144:147], v[120:123], v[0:3]
    ds_read_b64_tr_b16 v[188:189], v232 offset:8192
    s_add_u32 s68, s68, 1
    v_mfma_f32_16x16x32_bf16 v[4:7], v[144:147], v[124:127], v[4:7]
    ds_read_b64_tr_b16 v[190:191], v232 offset:12288
    s_and_b32 s68, s68, 3
    v_mfma_f32_16x16x32_bf16 v[8:11], v[144:147], v[128:131], v[8:11]
    ds_read_b64_tr_b16 v[192:193], v233 offset:8192
    s_cselect_b32 s65, 16384, s62
    v_mfma_f32_16x16x32_bf16 v[20:23], v[148:151], v[128:131], v[20:23]
    ds_read_b64_tr_b16 v[194:195], v233 offset:12288
    v_mfma_f32_16x16x32_bf16 v[16:19], v[148:151], v[124:127], v[16:19]
    ds_read_b64_tr_b16 v[196:197], v234 offset:8192
    v_mfma_f32_16x16x32_bf16 v[12:15], v[148:151], v[120:123], v[12:15]
    ds_read_b64_tr_b16 v[198:199], v234 offset:12288
    v_mfma_f32_16x16x32_bf16 v[24:27], v[152:155], v[120:123], v[24:27]
    ds_read_b64_tr_b16 v[200:201], v235 offset:8192
    v_mfma_f32_16x16x32_bf16 v[28:31], v[152:155], v[124:127], v[28:31]
    ds_read_b64_tr_b16 v[202:203], v235 offset:12288
    v_mfma_f32_16x16x32_bf16 v[32:35], v[152:155], v[128:131], v[32:35]
    ds_read_b64_tr_b16 v[204:205], v236 offset:8192
    v_add_u32 v232, s65, v232
    v_mfma_f32_16x16x32_bf16 v[44:47], v[156:159], v[128:131], v[44:47]
    ds_read_b64_tr_b16 v[206:207], v236 offset:12288
    v_add_u32_e64 v233, s65, v233
    v_mfma_f32_16x16x32_bf16 v[40:43], v[156:159], v[124:127], v[40:43]
    ds_read_b64_tr_b16 v[208:209], v237 offset:8192
    v_add_u32_e64 v234, s65, v234
    v_mfma_f32_16x16x32_bf16 v[36:39], v[156:159], v[120:123], v[36:39]
    ds_read_b64_tr_b16 v[210:211], v237 offset:12288
    v_add_u32_e64 v235, s65, v235
    v_mfma_f32_16x16x32_bf16 v[48:51], v[160:163], v[120:123], v[48:51]
    ds_read_b64_tr_b16 v[212:213], v238 offset:8192
    v_add_u32_e64 v236, s65, v236
    v_mfma_f32_16x16x32_bf16 v[52:55], v[160:163], v[124:127], v[52:55]
    ds_read_b64_tr_b16 v[214:215], v238 offset:12288
    v_add_u32_e64 v237, s65, v237
    v_mfma_f32_16x16x32_bf16 v[56:59], v[160:163], v[128:131], v[56:59]
    ds_read_b64_tr_b16 v[216:217], v239 offset:8192
    v_add_u32_e64 v238, s65, v238
    v_mfma_f32_16x16x32_bf16 v[68:71], v[164:167], v[128:131], v[68:71]
    ds_read_b64_tr_b16 v[218:219], v239 offset:12288
    v_mfma_f32_16x16x32_bf16 v[64:67], v[164:167], v[124:127], v[64:67]
    v_add_u32_e64 v239, s65, v239
    v_mfma_f32_16x16x32_bf16 v[60:63], v[164:167], v[120:123], v[60:63]
    buffer_load_dwordx4 v[108:111], v251, s[44:47], s94 offen offset:0 sc1
    v_mfma_f32_16x16x32_bf16 v[72:75], v[168:171], v[120:123], v[72:75]
    v_mfma_f32_16x16x32_bf16 v[76:79], v[168:171], v[124:127], v[76:79]
    buffer_load_dwordx4 v[112:115], v251, s[44:47], s94 offen offset:1024 sc1
    v_mfma_f32_16x16x32_bf16 v[80:83], v[168:171], v[128:131], v[80:83]
    v_mfma_f32_16x16x32_bf16 v[92:95], v[172:175], v[128:131], v[92:95]
    buffer_load_dwordx4 v[116:119], v251, s[44:47], s94 offen offset:2048 sc1
    v_mfma_f32_16x16x32_bf16 v[88:91], v[172:175], v[124:127], v[88:91]
    s_waitcnt lgkmcnt(0)
    s_barrier
    v_mfma_f32_16x16x32_bf16 v[84:87], v[172:175], v[120:123], v[84:87]
    s_mov_b32 s64, 4
.p2align 6
L_oloop:
    ds_read_b64_tr_b16 v[144:145], v232 offset:0
    v_mfma_f32_16x16x32_bf16 v[0:3], v[188:191], v[132:135], v[0:3]
    ds_read_b64_tr_b16 v[146:147], v232 offset:4096
    v_mfma_f32_16x16x32_bf16 v[4:7], v[188:191], v[136:139], v[4:7]
    ds_read_b64_tr_b16 v[148:149], v233 offset:0
    v_mfma_f32_16x16x32_bf16 v[8:11], v[188:191], v[140:143], v[8:11]
    ds_read_b64_tr_b16 v[150:151], v233 offset:4096
    v_mfma_f32_16x16x32_bf16 v[20:23], v[192:195], v[140:143], v[20:23]
    ds_read_b64_tr_b16 v[152:153], v234 offset:0
    v_mfma_f32_16x16x32_bf16 v[16:19], v[192:195], v[136:139], v[16:19]
    s_add_u32 s94, s92, s72
    ds_read_b64_tr_b16 v[154:155], v234 offset:4096
    v_mfma_f32_16x16x32_bf16 v[12:15], v[192:195], v[132:135], v[12:15]
    s_and_b32 s94, s94, 15
    ds_read_b64_tr_b16 v[156:157], v235 offset:0
    v_mfma_f32_16x16x32_bf16 v[24:27], v[196:199], v[132:135], v[24:27]
    s_mul_i32 s94, s94, 24576
    ds_read_b64_tr_b16 v[158:159], v235 offset:4096
    v_mfma_f32_16x16x32_bf16 v[28:31], v[196:199], v[136:139], v[28:31]
    s_lshr_b64 s[92:93], s[92:93], 4
    ds_read_b64_tr_b16 v[160:161], v236 offset:0
    v_mfma_f32_16x16x32_bf16 v[32:35], v[196:199], v[140:143], v[32:35]
    ds_read_b64_tr_b16 v[162:163], v236 offset:4096
    v_mfma_f32_16x16x32_bf16 v[44:47], v[200:203], v[140:143], v[44:47]
    ds_read_b64_tr_b16 v[164:165], v237 offset:0
    v_mfma_f32_16x16x32_bf16 v[40:43], v[200:203], v[136:139], v[40:43]
    ds_read_b64_tr_b16 v[166:167], v237 offset:4096
    v_mfma_f32_16x16x32_bf16 v[36:39], v[200:203], v[132:135], v[36:39]
    ds_read_b64_tr_b16 v[168:169], v238 offset:0
    v_mfma_f32_16x16x32_bf16 v[48:51], v[204:207], v[132:135], v[48:51]
    ds_read_b64_tr_b16 v[170:171], v238 offset:4096
    v_mfma_f32_16x16x32_bf16 v[52:55], v[204:207], v[136:139], v[52:55]
    ds_read_b64_tr_b16 v[172:173], v239 offset:0
    v_mfma_f32_16x16x32_bf16 v[56:59], v[204:207], v[140:143], v[56:59]
    ds_read_b64_tr_b16 v[174:175], v239 offset:4096
    v_mfma_f32_16x16x32_bf16 v[68:71], v[208:211], v[140:143], v[68:71]
    v_mfma_f32_16x16x32_bf16 v[64:67], v[208:211], v[136:139], v[64:67]
    v_mfma_f32_16x16x32_bf16 v[60:63], v[208:211], v[132:135], v[60:63]
    buffer_load_dwordx4 v[120:123], v240, s[44:47], s94 offen offset:0 sc1
    v_mfma_f32_16x16x32_bf16 v[72:75], v[212:215], v[132:135], v[72:75]
    v_mfma_f32_16x16x32_bf16 v[76:79], v[212:215], v[136:139], v[76:79]
    buffer_load_dwordx4 v[124:127], v240, s[44:47], s94 offen offset:1024 sc1
    v_mfma_f32_16x16x32_bf16 v[80:83], v[212:215], v[140:143], v[80:83]
    v_mfma_f32_16x16x32_bf16 v[92:95], v[216:219], v[140:143], v[92:95]
    buffer_load_dwordx4 v[128:131], v240, s[44:47], s94 offen offset:2048 sc1
    v_mfma_f32_16x16x32_bf16 v[88:91], v[216:219], v[136:139], v[88:91]
    s_waitcnt lgkmcnt(0)
    v_mfma_f32_16x16x32_bf16 v[84:87], v[216:219], v[132:135], v[84:87]
    s_waitcnt vmcnt(12)
    v_mfma_f32_16x16x32_bf16 v[0:3], v[144:147], v[176:179], v[0:3]
    ds_read_b64_tr_b16 v[188:189], v232 offset:8192
    s_add_u32 s68, s68, 1
    v_mfma_f32_16x16x32_bf16 v[4:7], v[144:147], v[180:183], v[4:7]
    ds_read_b64_tr_b16 v[190:191], v232 offset:12288
    s_and_b32 s68, s68, 3
    v_mfma_f32_16x16x32_bf16 v[8:11], v[144:147], v[184:187], v[8:11]
    ds_read_b64_tr_b16 v[192:193], v233 offset:8192
    s_cselect_b32 s65, 16384, s62
    v_mfma_f32_16x16x32_bf16 v[20:23], v[148:151], v[184:187], v[20:23]
    ds_read_b64_tr_b16 v[194:195], v233 offset:12288
    v_mfma_f32_16x16x32_bf16 v[16:19], v[148:151], v[180:183], v[16:19]
    ds_read_b64_tr_b16 v[196:197], v234 offset:8192
    v_mfma_f32_16x16x32_bf16 v[12:15], v[148:151], v[176:179], v[12:15]
    ds_read_b64_tr_b16 v[198:199], v234 offset:12288
    v_mfma_f32_16x16x32_bf16 v[24:27], v[152:155], v[176:179], v[24:27]
    ds_read_b64_tr_b16 v[200:201], v235 offset:8192
    v_mfma_f32_16x16x32_bf16 v[28:31], v[152:155], v[180:183], v[28:31]
    ds_read_b64_tr_b16 v[202:203], v235 offset:12288
    v_mfma_f32_16x16x32_bf16 v[32:35], v[152:155], v[184:187], v[32:35]
    ds_read_b64_tr_b16 v[204:205], v236 offset:8192
    v_add_u32 v232, s65, v232
    v_mfma_f32_16x16x32_bf16 v[44:47], v[156:159], v[184:187], v[44:47]
    ds_read_b64_tr_b16 v[206:207], v236 offset:12288
    v_add_u32_e64 v233, s65, v233
    v_mfma_f32_16x16x32_bf16 v[40:43], v[156:159], v[180:183], v[40:43]
    ds_read_b64_tr_b16 v[208:209], v237 offset:8192
    v_add_u32_e64 v234, s65, v234
    v_mfma_f32_16x16x32_bf16 v[36:39], v[156:159], v[176:179], v[36:39]
    ds_read_b64_tr_b16 v[210:211], v237 offset:12288
    v_add_u32_e64 v235, s65, v235
    v_mfma_f32_16x16x32_bf16 v[48:51], v[160:163], v[176:179], v[48:51]
    ds_read_b64_tr_b16 v[212:213], v238 offset:8192
    v_add_u32_e64 v236, s65, v236
    v_mfma_f32_16x16x32_bf16 v[52:55], v[160:163], v[180:183], v[52:55]
    ds_read_b64_tr_b16 v[214:215], v238 offset:12288
    v_add_u32_e64 v237, s65, v237
    v_mfma_f32_16x16x32_bf16 v[56:59], v[160:163], v[184:187], v[56:59]
    ds_read_b64_tr_b16 v[216:217], v239 offset:8192
    v_add_u32_e64 v238, s65, v238
    v_mfma_f32_16x16x32_bf16 v[68:71], v[164:167], v[184:187], v[68:71]
    ds_read_b64_tr_b16 v[218:219], v239 offset:12288
    v_mfma_f32_16x16x32_bf16 v[64:67], v[164:167], v[180:183], v[64:67]
    v_add_u32_e64 v239, s65, v239
    v_mfma_f32_16x16x32_bf16 v[60:63], v[164:167], v[176:179], v[60:63]
    buffer_load_dwordx4 v[132:135], v251, s[44:47], s94 offen offset:0 sc1
    v_mfma_f32_16x16x32_bf16 v[72:75], v[168:171], v[176:179], v[72:75]
    v_mfma_f32_16x16x32_bf16 v[76:79], v[168:171], v[180:183], v[76:79]
    buffer_load_dwordx4 v[136:139], v251, s[44:47], s94 offen offset:1024 sc1
    v_mfma_f32_16x16x32_bf16 v[80:83], v[168:171], v[184:187], v[80:83]
    v_mfma_f32_16x16x32_bf16 v[92:95], v[172:175], v[184:187], v[92:95]
    buffer_load_dwordx4 v[140:143], v251, s[44:47], s94 offen offset:2048 sc1
    v_mfma_f32_16x16x32_bf16 v[88:91], v[172:175], v[180:183], v[88:91]
    s_waitcnt lgkmcnt(0)
    s_barrier
    v_mfma_f32_16x16x32_bf16 v[84:87], v[172:175], v[176:179], v[84:87]
    s_waitcnt vmcnt(12)
    ds_read_b64_tr_b16 v[144:145], v232 offset:0
    v_mfma_f32_16x16x32_bf16 v[0:3], v[188:191], v[220:223], v[0:3]
    ds_read_b64_tr_b16 v[146:147], v232 offset:4096
    v_mfma_f32_16x16x32_bf16 v[4:7], v[188:191], v[224:227], v[4:7]
    ds_read_b64_tr_b16 v[148:149], v233 offset:0
    v_mfma_f32_16x16x32_bf16 v[8:11], v[188:191], v[228:231], v[8:11]
    ds_read_b64_tr_b16 v[150:151], v233 offset:4096
    v_mfma_f32_16x16x32_bf16 v[20:23], v[192:195], v[228:231], v[20:23]
    ds_read_b64_tr_b16 v[152:153], v234 offset:0
    v_mfma_f32_16x16x32_bf16 v[16:19], v[192:195], v[224:227], v[16:19]
    s_add_u32 s94, s92, s72
    ds_read_b64_tr_b16 v[154:155], v234 offset:4096
    v_mfma_f32_16x16x32_bf16 v[12:15], v[192:195], v[220:223], v[12:15]
    s_and_b32 s94, s94, 15
    ds_read_b64_tr_b16 v[156:157], v235 offset:0
    v_mfma_f32_16x16x32_bf16 v[24:27], v[196:199], v[220:223], v[24:27]
    s_mul_i32 s94, s94, 24576
    ds_read_b64_tr_b16 v[158:159], v235 offset:4096
    v_mfma_f32_16x16x32_bf16 v[28:31], v[196:199], v[224:227], v[28:31]
    s_lshr_b64 s[92:93], s[92:93], 4
    ds_read_b64_tr_b16 v[160:161], v236 offset:0
    v_mfma_f32_16x16x32_bf16 v[32:35], v[196:199], v[228:231], v[32:35]
    ds_read_b64_tr_b16 v[162:163], v236 offset:4096
    v_mfma_f32_16x16x32_bf16 v[44:47], v[200:203], v[228:231], v[44:47]
    ds_read_b64_tr_b16 v[164:165], v237 offset:0
    v_mfma_f32_16x16x32_bf16 v[40:43], v[200:203], v[224:227], v[40:43]
    ds_read_b64_tr_b16 v[166:167], v237 offset:4096
    v_mfma_f32_16x16x32_bf16 v[36:39], v[200:203], v[220:223], v[36:39]
    ds_read_b64_tr_b16 v[168:169], v238 offset:0
    v_mfma_f32_16x16x32_bf16 v[48:51], v[204:207], v[220:223], v[48:51]
    ds_read_b64_tr_b16 v[170:171], v238 offset:4096
    v_mfma_f32_16x16x32_bf16 v[52:55], v[204:207], v[224:227], v[52:55]
    ds_read_b64_tr_b16 v[172:173], v239 offset:0
    v_mfma_f32_16x16x32_bf16 v[56:59], v[204:207], v[228:231], v[56:59]
    ds_read_b64_tr_b16 v[174:175], v239 offset:4096
    v_mfma_f32_16x16x32_bf16 v[68:71], v[208:211], v[228:231], v[68:71]
    v_mfma_f32_16x16x32_bf16 v[64:67], v[208:211], v[224:227], v[64:67]
    v_mfma_f32_16x16x32_bf16 v[60:63], v[208:211], v[220:223], v[60:63]
    buffer_load_dwordx4 v[176:179], v240, s[44:47], s94 offen offset:0 sc1
    v_mfma_f32_16x16x32_bf16 v[72:75], v[212:215], v[220:223], v[72:75]
    v_mfma_f32_16x16x32_bf16 v[76:79], v[212:215], v[224:227], v[76:79]
    buffer_load_dwordx4 v[180:183], v240, s[44:47], s94 offen offset:1024 sc1
    v_mfma_f32_16x16x32_bf16 v[80:83], v[212:215], v[228:231], v[80:83]
    v_mfma_f32_16x16x32_bf16 v[92:95], v[216:219], v[228:231], v[92:95]
    buffer_load_dwordx4 v[184:187], v240, s[44:47], s94 offen offset:2048 sc1
    v_mfma_f32_16x16x32_bf16 v[88:91], v[216:219], v[224:227], v[88:91]
    s_waitcnt lgkmcnt(0)
    v_mfma_f32_16x16x32_bf16 v[84:87], v[216:219], v[220:223], v[84:87]
    s_waitcnt vmcnt(12)
    v_mfma_f32_16x16x32_bf16 v[0:3], v[144:147], v[96:99], v[0:3]
    ds_read_b64_tr_b16 v[188:189], v232 offset:8192
    s_add_u32 s68, s68, 1
    v_mfma_f32_16x16x32_bf16 v[4:7], v[144:147], v[100:103], v[4:7]
    ds_read_b64_tr_b16 v[190:191], v232 offset:12288
    s_and_b32 s68, s68, 3
    v_mfma_f32_16x16x32_bf16 v[8:11], v[144:147], v[104:107], v[8:11]
    ds_read_b64_tr_b16 v[192:193], v233 offset:8192
    s_cselect_b32 s65, 16384, s62
    v_mfma_f32_16x16x32_bf16 v[20:23], v[148:151], v[104:107], v[20:23]
    ds_read_b64_tr_b16 v[194:195], v233 offset:12288
    v_mfma_f32_16x16x32_bf16 v[16:19], v[148:151], v[100:103], v[16:19]
    ds_read_b64_tr_b16 v[196:197], v234 offset:8192
    v_mfma_f32_16x16x32_bf16 v[12:15], v[148:151], v[96:99], v[12:15]
    ds_read_b64_tr_b16 v[198:199], v234 offset:12288
    v_mfma_f32_16x16x32_bf16 v[24:27], v[152:155], v[96:99], v[24:27]
    ds_read_b64_tr_b16 v[200:201], v235 offset:8192
    v_mfma_f32_16x16x32_bf16 v[28:31], v[152:155], v[100:103], v[28:31]
    ds_read_b64_tr_b16 v[202:203], v235 offset:12288
    v_mfma_f32_16x16x32_bf16 v[32:35], v[152:155], v[104:107], v[32:35]
    ds_read_b64_tr_b16 v[204:205], v236 offset:8192
    v_add_u32_e64 v232, s65, v232
    v_mfma_f32_16x16x32_bf16 v[44:47], v[156:159], v[104:107], v[44:47]
    ds_read_b64_tr_b16 v[206:207], v236 offset:12288
    v_add_u32_e64 v233, s65, v233
    v_mfma_f32_16x16x32_bf16 v[40:43], v[156:159], v[100:103], v[40:43]
    ds_read_b64_tr_b16 v[208:209], v237 offset:8192
    v_add_u32_e64 v234, s65, v234
    v_mfma_f32_16x16x32_bf16 v[36:39], v[156:159], v[96:99], v[36:39]
    ds_read_b64_tr_b16 v[210:211], v237 offset:12288
    v_add_u32_e64 v235, s65, v235
    v_mfma_f32_16x16x32_bf16 v[48:51], v[160:163], v[96:99], v[48:51]
    ds_read_b64_tr_b16 v[212:213], v238 offset:8192
    v_add_u32_e64 v236, s65, v236
    v_mfma_f32_16x16x32_bf16 v[52:55], v[160:163], v[100:103], v[52:55]
    ds_read_b64_tr_b16 v[214:215], v238 offset:12288
    v_add_u32_e64 v237, s65, v237
    v_mfma_f32_16x16x32_bf16 v[56:59], v[160:163], v[104:107], v[56:59]
    ds_read_b64_tr_b16 v[216:217], v239 offset:8192
    v_add_u32_e64 v238, s65, v238
    v_mfma_f32_16x16x32_bf16 v[68:71], v[164:167], v[104:107], v[68:71]
    ds_read_b64_tr_b16 v[218:219], v239 offset:12288
    v_mfma_f32_16x16x32_bf16 v[64:67], v[164:167], v[100:103], v[64:67]
    v_add_u32_e64 v239, s65, v239
    v_mfma_f32_16x16x32_bf16 v[60:63], v[164:167], v[96:99], v[60:63]
    buffer_load_dwordx4 v[220:223], v251, s[44:47], s94 offen offset:0 sc1
    v_mfma_f32_16x16x32_bf16 v[72:75], v[168:171], v[96:99], v[72:75]
    v_mfma_f32_16x16x32_bf16 v[76:79], v[168:171], v[100:103], v[76:79]
    buffer_load_dwordx4 v[224:227], v251, s[44:47], s94 offen offset:1024 sc1
    v_mfma_f32_16x16x32_bf16 v[80:83], v[168:171], v[104:107], v[80:83]
    v_mfma_f32_16x16x32_bf16 v[92:95], v[172:175], v[104:107], v[92:95]
    buffer_load_dwordx4 v[228:231], v251, s[44:47], s94 offen offset:2048 sc1
    v_mfma_f32_16x16x32_bf16 v[88:91], v[172:175], v[100:103], v[88:91]
    s_waitcnt lgkmcnt(0)
    s_barrier
    v_mfma_f32_16x16x32_bf16 v[84:87], v[172:175], v[96:99], v[84:87]
    s_waitcnt vmcnt(12)
    ds_read_b64_tr_b16 v[144:145], v232 offset:0
    v_mfma_f32_16x16x32_bf16 v[0:3], v[188:191], v[108:111], v[0:3]
    ds_read_b64_tr_b16 v[146:147], v232 offset:4096
    v_mfma_f32_16x16x32_bf16 v[4:7], v[188:191], v[112:115], v[4:7]
    ds_read_b64_tr_b16 v[148:149], v233 offset:0
    v_mfma_f32_16x16x32_bf16 v[8:11], v[188:191], v[116:119], v[8:11]
    ds_read_b64_tr_b16 v[150:151], v233 offset:4096
    v_mfma_f32_16x16x32_bf16 v[20:23], v[192:195], v[116:119], v[20:23]
    ds_read_b64_tr_b16 v[152:153], v234 offset:0
    v_mfma_f32_16x16x32_bf16 v[16:19], v[192:195], v[112:115], v[16:19]
    s_add_u32 s94, s92, s72
    ds_read_b64_tr_b16 v[154:155], v234 offset:4096
    v_mfma_f32_16x16x32_bf16 v[12:15], v[192:195], v[108:111], v[12:15]
    s_and_b32 s94, s94, 15
    ds_read_b64_tr_b16 v[156:157], v235 offset:0
    v_mfma_f32_16x16x32_bf16 v[24:27], v[196:199], v[108:111], v[24:27]
    s_mul_i32 s94, s94, 24576
    ds_read_b64_tr_b16 v[158:159], v235 offset:4096
    v_mfma_f32_16x16x32_bf16 v[28:31], v[196:199], v[112:115], v[28:31]
    s_lshr_b64 s[92:93], s[92:93], 4
    ds_read_b64_tr_b16 v[160:161], v236 offset:0
    v_mfma_f32_16x16x32_bf16 v[32:35], v[196:199], v[116:119], v[32:35]
    ds_read_b64_tr_b16 v[162:163], v236 offset:4096
    v_mfma_f32_16x16x32_bf16 v[44:47], v[200:203], v[116:119], v[44:47]
    ds_read_b64_tr_b16 v[164:165], v237 offset:0
    v_mfma_f32_16x16x32_bf16 v[40:43], v[200:203], v[112:115], v[40:43]
    ds_read_b64_tr_b16 v[166:167], v237 offset:4096
    v_mfma_f32_16x16x32_bf16 v[36:39], v[200:203], v[108:111], v[36:39]
    ds_read_b64_tr_b16 v[168:169], v238 offset:0
    v_mfma_f32_16x16x32_bf16 v[48:51], v[204:207], v[108:111], v[48:51]
    ds_read_b64_tr_b16 v[170:171], v238 offset:4096
    v_mfma_f32_16x16x32_bf16 v[52:55], v[204:207], v[112:115], v[52:55]
    ds_read_b64_tr_b16 v[172:173], v239 offset:0
    v_mfma_f32_16x16x32_bf16 v[56:59], v[204:207], v[116:119], v[56:59]
    ds_read_b64_tr_b16 v[174:175], v239 offset:4096
    v_mfma_f32_16x16x32_bf16 v[68:71], v[208:211], v[116:119], v[68:71]
    v_mfma_f32_16x16x32_bf16 v[64:67], v[208:211], v[112:115], v[64:67]
    v_mfma_f32_16x16x32_bf16 v[60:63], v[208:211], v[108:111], v[60:63]
    buffer_load_dwordx4 v[96:99], v240, s[44:47], s94 offen offset:0 sc1
    v_mfma_f32_16x16x32_bf16 v[72:75], v[212:215], v[108:111], v[72:75]
    v_mfma_f32_16x16x32_bf16 v[76:79], v[212:215], v[112:115], v[76:79]
    buffer_load_dwordx4 v[100:103], v240, s[44:47], s94 offen offset:1024 sc1
    v_mfma_f32_16x16x32_bf16 v[80:83], v[212:215], v[116:119], v[80:83]
    v_mfma_f32_16x16x32_bf16 v[92:95], v[216:219], v[116:119], v[92:95]
    buffer_load_dwordx4 v[104:107], v240, s[44:47], s94 offen offset:2048 sc1
    v_mfma_f32_16x16x32_bf16 v[88:91], v[216:219], v[112:115], v[88:91]
    s_waitcnt lgkmcnt(0)
    v_mfma_f32_16x16x32_bf16 v[84:87], v[216:219], v[108:111], v[84:87]
    s_waitcnt vmcnt(12)
    v_mfma_f32_16x16x32_bf16 v[0:3], v[144:147], v[120:123], v[0:3]
    ds_read_b64_tr_b16 v[188:189], v232 offset:8192
    s_add_u32 s68, s68, 1
    v_mfma_f32_16x16x32_bf16 v[4:7], v[144:147], v[124:127], v[4:7]
    ds_read_b64_tr_b16 v[190:191], v232 offset:12288
    s_and_b32 s68, s68, 3
    v_mfma_f32_16x16x32_bf16 v[8:11], v[144:147], v[128:131], v[8:11]
    ds_read_b64_tr_b16 v[192:193], v233 offset:8192
    s_cselect_b32 s65, 16384, s62
    v_mfma_f32_16x16x32_bf16 v[20:23], v[148:151], v[128:131], v[20:23]
    ds_read_b64_tr_b16 v[194:195], v233 offset:12288
    v_mfma_f32_16x16x32_bf16 v[16:19], v[148:151], v[124:127], v[16:19]
    ds_read_b64_tr_b16 v[196:197], v234 offset:8192
    v_mfma_f32_16x16x32_bf16 v[12:15], v[148:151], v[120:123], v[12:15]
    ds_read_b64_tr_b16 v[198:199], v234 offset:12288
    s_sub_u32 s64, s64, 1
    v_mfma_f32_16x16x32_bf16 v[24:27], v[152:155], v[120:123], v[24:27]
    ds_read_b64_tr_b16 v[200:201], v235 offset:8192
    s_cmp_lg_u32 s64, 0
    v_mfma_f32_16x16x32_bf16 v[28:31], v[152:155], v[124:127], v[28:31]
    ds_read_b64_tr_b16 v[202:203], v235 offset:12288
    v_mfma_f32_16x16x32_bf16 v[32:35], v[152:155], v[128:131], v[32:35]
    ds_read_b64_tr_b16 v[204:205], v236 offset:8192
    v_add_u32_e64 v232, s65, v232
    v_mfma_f32_16x16x32_bf16 v[44:47], v[156:159], v[128:131], v[44:47]
    ds_read_b64_tr_b16 v[206:207], v236 offset:12288
    v_add_u32_e64 v233, s65, v233
    v_mfma_f32_16x16x32_bf16 v[40:43], v[156:159], v[124:127], v[40:43]
    ds_read_b64_tr_b16 v[208:209], v237 offset:8192
    v_add_u32_e64 v234, s65, v234
    v_mfma_f32_16x16x32_bf16 v[36:39], v[156:159], v[120:123], v[36:39]
    ds_read_b64_tr_b16 v[210:211], v237 offset:12288
    v_add_u32_e64 v235, s65, v235
    v_mfma_f32_16x16x32_bf16 v[48:51], v[160:163], v[120:123], v[48:51]
    ds_read_b64_tr_b16 v[212:213], v238 offset:8192
    v_add_u32_e64 v236, s65, v236
    v_mfma_f32_16x16x32_bf16 v[52:55], v[160:163], v[124:127], v[52:55]
    ds_read_b64_tr_b16 v[214:215], v238 offset:12288
    v_add_u32_e64 v237, s65, v237
    v_mfma_f32_16x16x32_bf16 v[56:59], v[160:163], v[128:131], v[56:59]
    ds_read_b64_tr_b16 v[216:217], v239 offset:8192
    v_add_u32_e64 v238, s65, v238
    v_mfma_f32_16x16x32_bf16 v[68:71], v[164:167], v[128:131], v[68:71]
    ds_read_b64_tr_b16 v[218:219], v239 offset:12288
    v_mfma_f32_16x16x32_bf16 v[64:67], v[164:167], v[124:127], v[64:67]
    v_add_u32_e64 v239, s65, v239
    v_mfma_f32_16x16x32_bf16 v[60:63], v[164:167], v[120:123], v[60:63]
    buffer_load_dwordx4 v[108:111], v251, s[44:47], s94 offen offset:0 sc1
    v_mfma_f32_16x16x32_bf16 v[72:75], v[168:171], v[120:123], v[72:75]
    v_mfma_f32_16x16x32_bf16 v[76:79], v[168:171], v[124:127], v[76:79]
    buffer_load_dwordx4 v[112:115], v251, s[44:47], s94 offen offset:1024 sc1
    v_mfma_f32_16x16x32_bf16 v[80:83], v[168:171], v[128:131], v[80:83]
    v_mfma_f32_16x16x32_bf16 v[92:95], v[172:175], v[128:131], v[92:95]
    buffer_load_dwordx4 v[116:119], v251, s[44:47], s94 offen offset:2048 sc1
    v_mfma_f32_16x16x32_bf16 v[88:91], v[172:175], v[124:127], v[88:91]
    s_waitcnt lgkmcnt(0)
    s_barrier
    v_mfma_f32_16x16x32_bf16 v[84:87], v[172:175], v[120:123], v[84:87]
    s_waitcnt vmcnt(12)
    s_cbranch_scc1 L_oloop
    v_mfma_f32_16x16x32_bf16 v[24:27], v[196:199], v[132:135], v[24:27]
    ds_read_b64_tr_b16 v[144:145], v234 offset:0
    v_mfma_f32_16x16x32_bf16 v[28:31], v[196:199], v[136:139], v[28:31]
    ds_read_b64_tr_b16 v[146:147], v234 offset:4096
    v_mfma_f32_16x16x32_bf16 v[32:35], v[196:199], v[140:143], v[32:35]
    ds_read_b64_tr_b16 v[148:149], v235 offset:0
    v_mfma_f32_16x16x32_bf16 v[44:47], v[200:203], v[140:143], v[44:47]
    ds_read_b64_tr_b16 v[150:151], v235 offset:4096
    v_mfma_f32_16x16x32_bf16 v[40:43], v[200:203], v[136:139], v[40:43]
    v_mfma_f32_16x16x32_bf16 v[36:39], v[200:203], v[132:135], v[36:39]
    v_mfma_f32_16x16x32_bf16 v[48:51], v[204:207], v[132:135], v[48:51]
    ds_read_b64_tr_b16 v[152:153], v236 offset:0
    v_mfma_f32_16x16x32_bf16 v[52:55], v[204:207], v[136:139], v[52:55]
    ds_read_b64_tr_b16 v[154:155], v236 offset:4096
    v_mfma_f32_16x16x32_bf16 v[56:59], v[204:207], v[140:143], v[56:59]
    ds_read_b64_tr_b16 v[156:157], v237 offset:0
    v_mfma_f32_16x16x32_bf16 v[68:71], v[208:211], v[140:143], v[68:71]
    ds_read_b64_tr_b16 v[158:159], v237 offset:4096
    v_mfma_f32_16x16x32_bf16 v[64:67], v[208:211], v[136:139], v[64:67]
    v_mfma_f32_16x16x32_bf16 v[60:63], v[208:211], v[132:135], v[60:63]
    v_mfma_f32_16x16x32_bf16 v[72:75], v[212:215], v[132:135], v[72:75]
    ds_read_b64_tr_b16 v[160:161], v234 offset:8192
    v_mfma_f32_16x16x32_bf16 v[76:79], v[212:215], v[136:139], v[76:79]
    ds_read_b64_tr_b16 v[162:163], v234 offset:12288
    v_mfma_f32_16x16x32_bf16 v[80:83], v[212:215], v[140:143], v[80:83]
    ds_read_b64_tr_b16 v[164:165], v235 offset:8192
    v_mfma_f32_16x16x32_bf16 v[92:95], v[216:219], v[140:143], v[92:95]
    ds_read_b64_tr_b16 v[166:167], v235 offset:12288
    v_mfma_f32_16x16x32_bf16 v[88:91], v[216:219], v[136:139], v[88:91]
    v_mfma_f32_16x16x32_bf16 v[84:87], v[216:219], v[132:135], v[84:87]
    s_barrier
    s_waitcnt vmcnt(9)
    s_waitcnt lgkmcnt(10)
    v_mfma_f32_16x16x32_bf16 v[24:27], v[144:147], v[176:179], v[24:27]
    ds_read_b64_tr_b16 v[168:169], v234 offset:16384
    v_mfma_f32_16x16x32_bf16 v[28:31], v[144:147], v[180:183], v[28:31]
    ds_read_b64_tr_b16 v[170:171], v234 offset:20480
    v_mfma_f32_16x16x32_bf16 v[32:35], v[144:147], v[184:187], v[32:35]
    ds_read_b64_tr_b16 v[172:173], v235 offset:16384
    s_waitcnt lgkmcnt(11)
    v_mfma_f32_16x16x32_bf16 v[44:47], v[148:151], v[184:187], v[44:47]
    ds_read_b64_tr_b16 v[174:175], v235 offset:20480
    v_mfma_f32_16x16x32_bf16 v[40:43], v[148:151], v[180:183], v[40:43]
    v_mfma_f32_16x16x32_bf16 v[36:39], v[148:151], v[176:179], v[36:39]
    s_waitcnt lgkmcnt(10)
    v_mfma_f32_16x16x32_bf16 v[48:51], v[152:155], v[176:179], v[48:51]
    ds_read_b64_tr_b16 v[144:145], v234 offset:24576
    v_mfma_f32_16x16x32_bf16 v[52:55], v[152:155], v[180:183], v[52:55]
    ds_read_b64_tr_b16 v[146:147], v234 offset:28672
    v_mfma_f32_16x16x32_bf16 v[56:59], v[152:155], v[184:187], v[56:59]
    ds_read_b64_tr_b16 v[148:149], v235 offset:24576
    s_waitcnt lgkmcnt(11)
    v_mfma_f32_16x16x32_bf16 v[68:71], v[156:159], v[184:187], v[68:71]
    ds_read_b64_tr_b16 v[150:151], v235 offset:28672
    v_mfma_f32_16x16x32_bf16 v[64:67], v[156:159], v[180:183], v[64:67]
    v_mfma_f32_16x16x32_bf16 v[60:63], v[156:159], v[176:179], v[60:63]
    s_waitcnt vmcnt(6)
    s_waitcnt lgkmcnt(10)
    v_mfma_f32_16x16x32_bf16 v[24:27], v[160:163], v[220:223], v[24:27]
    ds_read_b64_tr_b16 v[152:153], v236 offset:8192
    v_mfma_f32_16x16x32_bf16 v[28:31], v[160:163], v[224:227], v[28:31]
    ds_read_b64_tr_b16 v[154:155], v236 offset:12288
    v_mfma_f32_16x16x32_bf16 v[32:35], v[160:163], v[228:231], v[32:35]
    ds_read_b64_tr_b16 v[156:157], v237 offset:8192
    s_waitcnt lgkmcnt(11)
    v_mfma_f32_16x16x32_bf16 v[44:47], v[164:167], v[228:231], v[44:47]
    ds_read_b64_tr_b16 v[158:159], v237 offset:12288
    v_mfma_f32_16x16x32_bf16 v[40:43], v[164:167], v[224:227], v[40:43]
    v_mfma_f32_16x16x32_bf16 v[36:39], v[164:167], v[220:223], v[36:39]
    s_waitcnt vmcnt(3)
    s_waitcnt lgkmcnt(10)
    v_mfma_f32_16x16x32_bf16 v[24:27], v[168:171], v[96:99], v[24:27]
    ds_read_b64_tr_b16 v[160:161], v236 offset:16384
    v_mfma_f32_16x16x32_bf16 v[28:31], v[168:171], v[100:103], v[28:31]
    ds_read_b64_tr_b16 v[162:163], v236 offset:20480
    v_mfma_f32_16x16x32_bf16 v[32:35], v[168:171], v[104:107], v[32:35]
    ds_read_b64_tr_b16 v[164:165], v237 offset:16384
    s_waitcnt lgkmcnt(11)
    v_mfma_f32_16x16x32_bf16 v[44:47], v[172:175], v[104:107], v[44:47]
    ds_read_b64_tr_b16 v[166:167], v237 offset:20480
    v_mfma_f32_16x16x32_bf16 v[40:43], v[172:175], v[100:103], v[40:43]
    v_mfma_f32_16x16x32_bf16 v[36:39], v[172:175], v[96:99], v[36:39]
    s_waitcnt vmcnt(0)
    s_waitcnt lgkmcnt(10)
    v_mfma_f32_16x16x32_bf16 v[24:27], v[144:147], v[108:111], v[24:27]
    ds_read_b64_tr_b16 v[168:169], v236 offset:24576
    v_mfma_f32_16x16x32_bf16 v[28:31], v[144:147], v[112:115], v[28:31]
    ds_read_b64_tr_b16 v[170:171], v236 offset:28672
    v_mfma_f32_16x16x32_bf16 v[32:35], v[144:147], v[116:119], v[32:35]
    ds_read_b64_tr_b16 v[172:173], v237 offset:24576
    s_waitcnt lgkmcnt(11)
    v_mfma_f32_16x16x32_bf16 v[44:47], v[148:151], v[116:119], v[44:47]
    ds_read_b64_tr_b16 v[174:175], v237 offset:28672
    v_mfma_f32_16x16x32_bf16 v[40:43], v[148:151], v[112:115], v[40:43]
    v_mfma_f32_16x16x32_bf16 v[36:39], v[148:151], v[108:111], v[36:39]
    s_waitcnt lgkmcnt(10)
    v_mfma_f32_16x16x32_bf16 v[48:51], v[152:155], v[220:223], v[48:51]
    s_xor_b32 s60, s2, 1
    ds_read_b64_tr_b16 v[144:145], v238 offset:0
    v_mfma_f32_16x16x32_bf16 v[52:55], v[152:155], v[224:227], v[52:55]
    s_mul_i32 s60, s60, 36864
    ds_read_b64_tr_b16 v[146:147], v238 offset:4096
    v_mfma_f32_16x16x32_bf16 v[56:59], v[152:155], v[228:231], v[56:59]
    s_add_u32 s60, s60, 0
    ds_read_b64_tr_b16 v[148:149], v239 offset:0
    v_cvt_pk_bf16_f32 v128, v32, v33
    v_cvt_pk_bf16_f32 v129, v34, v35
    s_waitcnt lgkmcnt(11)
    v_mfma_f32_16x16x32_bf16 v[68:71], v[156:159], v[228:231], v[68:71]
    ds_read_b64_tr_b16 v[150:151], v239 offset:4096
    v_cvt_pk_bf16_f32 v130, v44, v45
    v_cvt_pk_bf16_f32 v131, v46, v47
    v_mfma_f32_16x16x32_bf16 v[64:67], v[156:159], v[224:227], v[64:67]
    buffer_store_dwordx4 v[128:131], v241, s[44:47], s60 offen offset:2048 sc1
    v_cvt_pk_bf16_f32 v124, v28, v29
    v_cvt_pk_bf16_f32 v125, v30, v31
    v_mfma_f32_16x16x32_bf16 v[60:63], v[156:159], v[220:223], v[60:63]
    v_cvt_pk_bf16_f32 v126, v40, v41
    v_cvt_pk_bf16_f32 v127, v42, v43
    s_waitcnt lgkmcnt(10)
    v_mfma_f32_16x16x32_bf16 v[48:51], v[160:163], v[96:99], v[48:51]
    buffer_store_dwordx4 v[124:127], v241, s[44:47], s60 offen offset:1024 sc1
    ds_read_b64_tr_b16 v[152:153], v238 offset:8192
    v_cvt_pk_bf16_f32 v120, v24, v25
    v_cvt_pk_bf16_f32 v121, v26, v27
    v_mfma_f32_16x16x32_bf16 v[52:55], v[160:163], v[100:103], v[52:55]
    ds_read_b64_tr_b16 v[154:155], v238 offset:12288
    v_cvt_pk_bf16_f32 v122, v36, v37
    v_cvt_pk_bf16_f32 v123, v38, v39
    v_mfma_f32_16x16x32_bf16 v[56:59], v[160:163], v[104:107], v[56:59]
    buffer_store_dwordx4 v[120:123], v241, s[44:47], s60 offen offset:0 sc1
    ds_read_b64_tr_b16 v[156:157], v239 offset:8192
    s_waitcnt lgkmcnt(11)
    v_mfma_f32_16x16x32_bf16 v[68:71], v[164:167], v[104:107], v[68:71]
    ds_read_b64_tr_b16 v[158:159], v239 offset:12288
    v_mfma_f32_16x16x32_bf16 v[64:67], v[164:167], v[100:103], v[64:67]
    v_mfma_f32_16x16x32_bf16 v[60:63], v[164:167], v[96:99], v[60:63]
    s_waitcnt lgkmcnt(10)
    v_mfma_f32_16x16x32_bf16 v[48:51], v[168:171], v[108:111], v[48:51]
    ds_read_b64_tr_b16 v[160:161], v238 offset:16384
    v_mfma_f32_16x16x32_bf16 v[52:55], v[168:171], v[112:115], v[52:55]
    ds_read_b64_tr_b16 v[162:163], v238 offset:20480
    v_mfma_f32_16x16x32_bf16 v[56:59], v[168:171], v[116:119], v[56:59]
    ds_read_b64_tr_b16 v[164:165], v239 offset:16384
    s_waitcnt lgkmcnt(11)
    v_mfma_f32_16x16x32_bf16 v[68:71], v[172:175], v[116:119], v[68:71]
    ds_read_b64_tr_b16 v[166:167], v239 offset:20480
    v_mfma_f32_16x16x32_bf16 v[64:67], v[172:175], v[112:115], v[64:67]
    v_mfma_f32_16x16x32_bf16 v[60:63], v[172:175], v[108:111], v[60:63]
    s_waitcnt lgkmcnt(10)
    v_mfma_f32_16x16x32_bf16 v[72:75], v[144:147], v[176:179], v[72:75]
    s_xor_b32 s60, s2, 2
    ds_read_b64_tr_b16 v[168:169], v238 offset:24576
    v_mfma_f32_16x16x32_bf16 v[76:79], v[144:147], v[180:183], v[76:79]
    s_mul_i32 s60, s60, 36864
    ds_read_b64_tr_b16 v[170:171], v238 offset:28672
    v_mfma_f32_16x16x32_bf16 v[80:83], v[144:147], v[184:187], v[80:83]
    s_add_u32 s60, s60, 3072
    ds_read_b64_tr_b16 v[172:173], v239 offset:24576
    v_cvt_pk_bf16_f32 v204, v56, v57
    v_cvt_pk_bf16_f32 v205, v58, v59
    s_waitcnt lgkmcnt(11)
    v_mfma_f32_16x16x32_bf16 v[92:95], v[148:151], v[184:187], v[92:95]
    ds_read_b64_tr_b16 v[174:175], v239 offset:28672
    v_cvt_pk_bf16_f32 v206, v68, v69
    v_cvt_pk_bf16_f32 v207, v70, v71
    v_mfma_f32_16x16x32_bf16 v[88:91], v[148:151], v[180:183], v[88:91]
    buffer_store_dwordx4 v[204:207], v241, s[44:47], s60 offen offset:2048 sc1
    v_cvt_pk_bf16_f32 v200, v52, v53
    v_cvt_pk_bf16_f32 v201, v54, v55
    v_mfma_f32_16x16x32_bf16 v[84:87], v[148:151], v[176:179], v[84:87]
    v_cvt_pk_bf16_f32 v202, v64, v65
    v_cvt_pk_bf16_f32 v203, v66, v67
    s_waitcnt lgkmcnt(10)
    v_mfma_f32_16x16x32_bf16 v[72:75], v[152:155], v[220:223], v[72:75]
    buffer_store_dwordx4 v[200:203], v241, s[44:47], s60 offen offset:1024 sc1
    v_cvt_pk_bf16_f32 v196, v48, v49
    v_cvt_pk_bf16_f32 v197, v50, v51
    v_mfma_f32_16x16x32_bf16 v[76:79], v[152:155], v[224:227], v[76:79]
    v_cvt_pk_bf16_f32 v198, v60, v61
    v_cvt_pk_bf16_f32 v199, v62, v63
    v_mfma_f32_16x16x32_bf16 v[80:83], v[152:155], v[228:231], v[80:83]
    buffer_store_dwordx4 v[196:199], v241, s[44:47], s60 offen offset:0 sc1
    s_waitcnt lgkmcnt(8)
    v_mfma_f32_16x16x32_bf16 v[92:95], v[156:159], v[228:231], v[92:95]
    v_mfma_f32_16x16x32_bf16 v[88:91], v[156:159], v[224:227], v[88:91]
    v_mfma_f32_16x16x32_bf16 v[84:87], v[156:159], v[220:223], v[84:87]
    s_waitcnt lgkmcnt(6)
    v_mfma_f32_16x16x32_bf16 v[72:75], v[160:163], v[96:99], v[72:75]
    ds_read_b64_tr_b16 v[144:145], v232 offset:0
    v_mfma_f32_16x16x32_bf16 v[76:79], v[160:163], v[100:103], v[76:79]
    ds_read_b64_tr_b16 v[146:147], v232 offset:4096
    v_mfma_f32_16x16x32_bf16 v[80:83], v[160:163], v[104:107], v[80:83]
    ds_read_b64_tr_b16 v[148:149], v233 offset:0
    s_waitcnt lgkmcnt(7)
    v_mfma_f32_16x16x32_bf16 v[92:95], v[164:167], v[104:107], v[92:95]
    ds_read_b64_tr_b16 v[150:151], v233 offset:4096
    v_mfma_f32_16x16x32_bf16 v[88:91], v[164:167], v[100:103], v[88:91]
    v_mfma_f32_16x16x32_bf16 v[84:87], v[164:167], v[96:99], v[84:87]
    s_waitcnt lgkmcnt(6)
    v_mfma_f32_16x16x32_bf16 v[72:75], v[168:171], v[108:111], v[72:75]
    ds_read_b64_tr_b16 v[152:153], v232 offset:8192
    v_mfma_f32_16x16x32_bf16 v[76:79], v[168:171], v[112:115], v[76:79]
    ds_read_b64_tr_b16 v[154:155], v232 offset:12288
    v_mfma_f32_16x16x32_bf16 v[80:83], v[168:171], v[116:119], v[80:83]
    ds_read_b64_tr_b16 v[156:157], v233 offset:8192
    s_waitcnt lgkmcnt(7)
    v_mfma_f32_16x16x32_bf16 v[92:95], v[172:175], v[116:119], v[92:95]
    ds_read_b64_tr_b16 v[158:159], v233 offset:12288
    v_mfma_f32_16x16x32_bf16 v[88:91], v[172:175], v[112:115], v[88:91]
    v_mfma_f32_16x16x32_bf16 v[84:87], v[172:175], v[108:111], v[84:87]
    v_mfma_f32_16x16x32_bf16 v[0:3], v[188:191], v[132:135], v[0:3]
    s_xor_b32 s60, s2, 3
    ds_read_b64_tr_b16 v[160:161], v232 offset:16384
    v_mfma_f32_16x16x32_bf16 v[4:7], v[188:191], v[136:139], v[4:7]
    s_mul_i32 s60, s60, 36864
    ds_read_b64_tr_b16 v[162:163], v232 offset:20480
    v_mfma_f32_16x16x32_bf16 v[8:11], v[188:191], v[140:143], v[8:11]
    s_add_u32 s60, s60, 6144
    ds_read_b64_tr_b16 v[164:165], v233 offset:16384
    v_cvt_pk_bf16_f32 v216, v80, v81
    v_cvt_pk_bf16_f32 v217, v82, v83
    v_mfma_f32_16x16x32_bf16 v[20:23], v[192:195], v[140:143], v[20:23]
    ds_read_b64_tr_b16 v[166:167], v233 offset:20480
    v_cvt_pk_bf16_f32 v218, v92, v93
    v_cvt_pk_bf16_f32 v219, v94, v95
    v_mfma_f32_16x16x32_bf16 v[16:19], v[192:195], v[136:139], v[16:19]
    buffer_store_dwordx4 v[216:219], v241, s[44:47], s60 offen offset:2048 sc1
    v_cvt_pk_bf16_f32 v212, v76, v77
    v_cvt_pk_bf16_f32 v213, v78, v79
    v_mfma_f32_16x16x32_bf16 v[12:15], v[192:195], v[132:135], v[12:15]
    v_cvt_pk_bf16_f32 v214, v88, v89
    v_cvt_pk_bf16_f32 v215, v90, v91
    s_waitcnt lgkmcnt(10)
    v_mfma_f32_16x16x32_bf16 v[0:3], v[144:147], v[176:179], v[0:3]
    buffer_store_dwordx4 v[212:215], v241, s[44:47], s60 offen offset:1024 sc1
    ds_read_b64_tr_b16 v[168:169], v232 offset:24576
    v_cvt_pk_bf16_f32 v208, v72, v73
    v_cvt_pk_bf16_f32 v209, v74, v75
    v_mfma_f32_16x16x32_bf16 v[4:7], v[144:147], v[180:183], v[4:7]
    ds_read_b64_tr_b16 v[170:171], v232 offset:28672
    v_cvt_pk_bf16_f32 v210, v84, v85
    v_cvt_pk_bf16_f32 v211, v86, v87
    v_mfma_f32_16x16x32_bf16 v[8:11], v[144:147], v[184:187], v[8:11]
    buffer_store_dwordx4 v[208:211], v241, s[44:47], s60 offen offset:0 sc1
    ds_read_b64_tr_b16 v[172:173], v233 offset:24576
    s_waitcnt lgkmcnt(11)
    v_mfma_f32_16x16x32_bf16 v[20:23], v[148:151], v[184:187], v[20:23]
    ds_read_b64_tr_b16 v[174:175], v233 offset:28672
    v_mfma_f32_16x16x32_bf16 v[16:19], v[148:151], v[180:183], v[16:19]
    v_mfma_f32_16x16x32_bf16 v[12:15], v[148:151], v[176:179], v[12:15]
    s_waitcnt lgkmcnt(10)
    v_mfma_f32_16x16x32_bf16 v[0:3], v[152:155], v[220:223], v[0:3]
    v_mfma_f32_16x16x32_bf16 v[4:7], v[152:155], v[224:227], v[4:7]
    v_mfma_f32_16x16x32_bf16 v[8:11], v[152:155], v[228:231], v[8:11]
    s_waitcnt lgkmcnt(8)
    v_mfma_f32_16x16x32_bf16 v[20:23], v[156:159], v[228:231], v[20:23]
    v_mfma_f32_16x16x32_bf16 v[16:19], v[156:159], v[224:227], v[16:19]
    v_mfma_f32_16x16x32_bf16 v[12:15], v[156:159], v[220:223], v[12:15]
    s_waitcnt lgkmcnt(6)
    v_mfma_f32_16x16x32_bf16 v[0:3], v[160:163], v[96:99], v[0:3]
    v_mfma_f32_16x16x32_bf16 v[4:7], v[160:163], v[100:103], v[4:7]
    v_mfma_f32_16x16x32_bf16 v[8:11], v[160:163], v[104:107], v[8:11]
    s_waitcnt lgkmcnt(4)
    v_mfma_f32_16x16x32_bf16 v[20:23], v[164:167], v[104:107], v[20:23]
    v_mfma_f32_16x16x32_bf16 v[16:19], v[164:167], v[100:103], v[16:19]
    v_mfma_f32_16x16x32_bf16 v[12:15], v[164:167], v[96:99], v[12:15]
    s_waitcnt lgkmcnt(2)
    v_mfma_f32_16x16x32_bf16 v[0:3], v[168:171], v[108:111], v[0:3]
    v_mfma_f32_16x16x32_bf16 v[4:7], v[168:171], v[112:115], v[4:7]
    v_mfma_f32_16x16x32_bf16 v[8:11], v[168:171], v[116:119], v[8:11]
    s_waitcnt lgkmcnt(0)
    v_mfma_f32_16x16x32_bf16 v[20:23], v[172:175], v[116:119], v[20:23]
    v_mfma_f32_16x16x32_bf16 v[16:19], v[172:175], v[112:115], v[16:19]
    v_mfma_f32_16x16x32_bf16 v[12:15], v[172:175], v[108:111], v[12:15]
    s_waitcnt vmcnt(0)
    s_mov_b64 exec, 14
    buffer_store_dword v245, v244, s[44:47], 0 offen sc1
    s_mov_b64 exec, -1
    s_mov_b32 s73, 0
L_poll2:
    buffer_load_dword v242, v246, s[44:47], 0 offen sc1
    s_add_u32 s73, s73, 1
    s_cmp_ge_u32 s73, 400000
    s_cbranch_scc1 L_poll2_done
    s_waitcnt vmcnt(0)
    v_cmp_ne_u32 vcc, 1, v242
    s_cbranch_vccnz L_poll2
L_poll2_done:
    s_mul_i32 s60, s2, 36864
    s_add_u32 s61, s60, 3072
    s_add_u32 s62, s60, 6144
    s_mov_b32 s66, 0xffff0000
    buffer_load_dwordx4 v[24:27], v241, s[44:47], s60 offen offset:0 sc1
    buffer_load_dwordx4 v[28:31], v241, s[44:47], s60 offen offset:1024 sc1
    buffer_load_dwordx4 v[32:35], v241, s[44:47], s60 offen offset:2048 sc1
    buffer_load_dwordx4 v[36:39], v241, s[44:47], s61 offen offset:0 sc1
    buffer_load_dwordx4 v[40:43], v241, s[44:47], s61 offen offset:1024 sc1
    buffer_load_dwordx4 v[44:47], v241, s[44:47], s61 offen offset:2048 sc1
    buffer_load_dwordx4 v[48:51], v241, s[44:47], s62 offen offset:0 sc1
    buffer_load_dwordx4 v[52:55], v241, s[44:47], s62 offen offset:1024 sc1
    buffer_load_dwordx4 v[56:59], v241, s[44:47], s62 offen offset:2048 sc1
    s_waitcnt vmcnt(8)
    v_lshlrev_b32 v64, 16, v24
    v_and_b32_e64 v65, s66, v24
    v_pk_add_f32 v[0:1], v[0:1], v[64:65]
    v_lshlrev_b32 v64, 16, v25
    v_and_b32 v65, s66, v25
    v_pk_add_f32 v[2:3], v[2:3], v[64:65]
    v_lshlrev_b32 v64, 16, v26
    v_and_b32 v65, s66, v26
    v_pk_add_f32 v[12:13], v[12:13], v[64:65]
    v_lshlrev_b32 v64, 16, v27
    v_and_b32 v65, s66, v27
    v_pk_add_f32 v[14:15], v[14:15], v[64:65]
    s_waitcnt vmcnt(7)
    v_lshlrev_b32 v64, 16, v28
    v_and_b32_e64 v65, s66, v28
    v_pk_add_f32 v[4:5], v[4:5], v[64:65]
    v_lshlrev_b32 v64, 16, v29
    v_and_b32 v65, s66, v29
    v_pk_add_f32 v[6:7], v[6:7], v[64:65]
    v_lshlrev_b32 v64, 16, v30
    v_and_b32 v65, s66, v30
    v_pk_add_f32 v[16:17], v[16:17], v[64:65]
    v_lshlrev_b32 v64, 16, v31
    v_and_b32 v65, s66, v31
    v_pk_add_f32 v[18:19], v[18:19], v[64:65]
    s_waitcnt vmcnt(6)
    v_lshlrev_b32 v64, 16, v32
    v_and_b32_e64 v65, s66, v32
    v_pk_add_f32 v[8:9], v[8:9], v[64:65]
    v_lshlrev_b32 v64, 16, v33
    v_and_b32 v65, s66, v33
    v_pk_add_f32 v[10:11], v[10:11], v[64:65]
    v_lshlrev_b32 v64, 16, v34
    v_and_b32 v65, s66, v34
    v_pk_add_f32 v[20:21], v[20:21], v[64:65]
    v_lshlrev_b32 v64, 16, v35
    v_and_b32 v65, s66, v35
    v_pk_add_f32 v[22:23], v[22:23], v[64:65]
    s_waitcnt vmcnt(5)
    v_lshlrev_b32 v64, 16, v36
    v_and_b32_e64 v65, s66, v36
    v_pk_add_f32 v[0:1], v[0:1], v[64:65]
    v_lshlrev_b32 v64, 16, v37
    v_and_b32 v65, s66, v37
    v_pk_add_f32 v[2:3], v[2:3], v[64:65]
    v_lshlrev_b32 v64, 16, v38
    v_and_b32 v65, s66, v38
    v_pk_add_f32 v[12:13], v[12:13], v[64:65]
    v_lshlrev_b32 v64, 16, v39
    v_and_b32 v65, s66, v39
    v_pk_add_f32 v[14:15], v[14:15], v[64:65]
    s_waitcnt vmcnt(4)
    v_lshlrev_b32 v64, 16, v40
    v_and_b32_e64 v65, s66, v40
    v_pk_add_f32 v[4:5], v[4:5], v[64:65]
    v_lshlrev_b32 v64, 16, v41
    v_and_b32 v65, s66, v41
    v_pk_add_f32 v[6:7], v[6:7], v[64:65]
    v_lshlrev_b32 v64, 16, v42
    v_and_b32 v65, s66, v42
    v_pk_add_f32 v[16:17], v[16:17], v[64:65]
    v_lshlrev_b32 v64, 16, v43
    v_and_b32 v65, s66, v43
    v_pk_add_f32 v[18:19], v[18:19], v[64:65]
    s_waitcnt vmcnt(3)
    v_lshlrev_b32 v64, 16, v44
    v_and_b32_e64 v65, s66, v44
    v_pk_add_f32 v[8:9], v[8:9], v[64:65]
    v_lshlrev_b32 v64, 16, v45
    v_and_b32 v65, s66, v45
    v_pk_add_f32 v[10:11], v[10:11], v[64:65]
    v_lshlrev_b32 v64, 16, v46
    v_and_b32 v65, s66, v46
    v_pk_add_f32 v[20:21], v[20:21], v[64:65]
    v_lshlrev_b32 v64, 16, v47
    v_and_b32 v65, s66, v47
    v_pk_add_f32 v[22:23], v[22:23], v[64:65]
    s_waitcnt vmcnt(2)
    v_lshlrev_b32 v64, 16, v48
    v_and_b32_e64 v65, s66, v48
    v_pk_add_f32 v[0:1], v[0:1], v[64:65]
    v_lshlrev_b32 v64, 16, v49
    v_and_b32 v65, s66, v49
    v_pk_add_f32 v[2:3], v[2:3], v[64:65]
    v_lshlrev_b32 v64, 16, v50
    v_and_b32 v65, s66, v50
    v_pk_add_f32 v[12:13], v[12:13], v[64:65]
    v_lshlrev_b32 v64, 16, v51
    v_and_b32 v65, s66, v51
    v_pk_add_f32 v[14:15], v[14:15], v[64:65]
    s_waitcnt vmcnt(1)
    v_lshlrev_b32 v64, 16, v52
    v_and_b32_e64 v65, s66, v52
    v_pk_add_f32 v[4:5], v[4:5], v[64:65]
    v_lshlrev_b32 v64, 16, v53
    v_and_b32 v65, s66, v53
    v_pk_add_f32 v[6:7], v[6:7], v[64:65]
    v_lshlrev_b32 v64, 16, v54
    v_and_b32 v65, s66, v54
    v_pk_add_f32 v[16:17], v[16:17], v[64:65]
    v_lshlrev_b32 v64, 16, v55
    v_and_b32 v65, s66, v55
    v_pk_add_f32 v[18:19], v[18:19], v[64:65]
    s_waitcnt vmcnt(0)
    v_lshlrev_b32 v64, 16, v56
    v_and_b32_e64 v65, s66, v56
    v_pk_add_f32 v[8:9], v[8:9], v[64:65]
    v_lshlrev_b32 v64, 16, v57
    v_and_b32 v65, s66, v57
    v_pk_add_f32 v[10:11], v[10:11], v[64:65]
    v_lshlrev_b32 v64, 16, v58
    v_and_b32 v65, s66, v58
    v_pk_add_f32 v[20:21], v[20:21], v[64:65]
    v_lshlrev_b32 v64, 16, v59
    v_and_b32 v65, s66, v59
    v_pk_add_f32 v[22:23], v[22:23], v[64:65]
    v_cvt_pk_bf16_f32 v96, v0, v1
    v_cvt_pk_bf16_f32 v97, v2, v3
    v_cvt_pk_bf16_f32 v100, v4, v5
    v_cvt_pk_bf16_f32 v101, v6, v7
    v_cvt_pk_bf16_f32 v104, v8, v9
    v_cvt_pk_bf16_f32 v105, v10, v11
    v_cvt_pk_bf16_f32 v98, v12, v13
    v_cvt_pk_bf16_f32 v99, v14, v15
    v_cvt_pk_bf16_f32 v102, v16, v17
    v_cvt_pk_bf16_f32 v103, v18, v19
    v_cvt_pk_bf16_f32 v106, v20, v21
    v_cvt_pk_bf16_f32 v107, v22, v23
    v_permlane16_swap_b32 v96, v98
    v_permlane16_swap_b32 v97, v99
    v_permlane16_swap_b32 v100, v102
    v_permlane16_swap_b32 v101, v103
    v_permlane16_swap_b32 v104, v106
    v_permlane16_swap_b32 v105, v107
    ds_bpermute_b32 v96, v252, v96
    ds_bpermute_b32 v97, v252, v97
    ds_bpermute_b32 v98, v252, v98
    ds_bpermute_b32 v99, v252, v99
    ds_bpermute_b32 v100, v252, v100
    ds_bpermute_b32 v101, v252, v101
    ds_bpermute_b32 v102, v252, v102
    ds_bpermute_b32 v103, v252, v103
    ds_bpermute_b32 v104, v252, v104
    ds_bpermute_b32 v105, v252, v105
    ds_bpermute_b32 v106, v252, v106
    ds_bpermute_b32 v107, v252, v107
    s_mov_b32 s60, 0
    s_waitcnt lgkmcnt(8)
    buffer_store_dwordx4 v[96:99], v248, s[40:43], s60 offen
    s_mov_b32 s60, 65536
    s_waitcnt lgkmcnt(4)
    buffer_store_dwordx4 v[100:103], v248, s[40:43], s60 offen
    s_mov_b32 s60, 131072
    s_waitcnt lgkmcnt(0)
    buffer_store_dwordx4 v[104:107], v248, s[40:43], s60 offen
L_exit:
    s_endpgm
L_count:
    s_lshl_b32 s60, 1, s75
    v_mov_b32_e64 v242, s60
    s_mov_b64 exec, 1
    s_waitcnt vmcnt(0)
    buffer_atomic_add v242, v243, s[48:51], 0 offen
    s_mov_b64 exec, -1
    s_branch L_counted
L_ahook:
    s_cmp_eq_u32 s64, 1
    s_cbranch_scc1 L_judge
    v_and_b32 v235, 3, v243
    v_xor_b32 v235, s76, v235
    v_lshlrev_b32_e64 v235, 2, v235
    buffer_load_dword v242, v235, s[48:51], 0 offen sc1
    s_branch L_ahooked
L_judge:
    s_waitcnt vmcnt(0)
    v_lshrrev_b32_e64 v235, 4, v242
    v_and_b32 v235, 0x0f0f0f0f, v235
    v_and_b32 v236, 0x0f0f0f0f, v242
    v_add_u32_e64 v235, v235, v236
    v_sad_u8 v235, v235, 0, 0
    v_readfirstlane_b32 s61, v242
    v_cmp_ne_u32 vcc, 8, v235
    s_lshl_b32 s60, 8, s75
    s_cmp_eq_u32 s60, s61
    s_cselect_b32 s74, 1, 0
    s_cmp_eq_u64 vcc, 0
    s_cselect_b32 s74, s74, 2
    v_mov_b32 v242, 1
    s_branch L_ahooked
L_up_0:
    s_waitcnt lgkmcnt(0)
    v_mfma_f32_16x16x32_bf16 v[24:27], v[152:155], v[200:203], v[24:27]
    v_mfma_f32_16x16x32_bf16 v[28:31], v[152:155], v[204:207], v[28:31]
    v_mfma_f32_16x16x32_bf16 v[32:35], v[152:155], v[208:211], v[32:35]
    v_mfma_f32_16x16x32_bf16 v[44:47], v[156:159], v[208:211], v[44:47]
    v_mfma_f32_16x16x32_bf16 v[40:43], v[156:159], v[204:207], v[40:43]
    v_mfma_f32_16x16x32_bf16 v[36:39], v[156:159], v[200:203], v[36:39]
    v_mfma_f32_16x16x32_bf16 v[48:51], v[160:163], v[200:203], v[48:51]
    v_mfma_f32_16x16x32_bf16 v[52:55], v[160:163], v[204:207], v[52:55]
    v_mfma_f32_16x16x32_bf16 v[56:59], v[160:163], v[208:211], v[56:59]
    v_mfma_f32_16x16x32_bf16 v[68:71], v[164:167], v[208:211], v[68:71]
    v_mfma_f32_16x16x32_bf16 v[64:67], v[164:167], v[204:207], v[64:67]
    v_mfma_f32_16x16x32_bf16 v[60:63], v[164:167], v[200:203], v[60:63]
    v_mfma_f32_16x16x32_bf16 v[72:75], v[168:171], v[200:203], v[72:75]
    v_mfma_f32_16x16x32_bf16 v[76:79], v[168:171], v[204:207], v[76:79]
    v_mfma_f32_16x16x32_bf16 v[80:83], v[168:171], v[208:211], v[80:83]
    v_mfma_f32_16x16x32_bf16 v[92:95], v[172:175], v[208:211], v[92:95]
    v_mfma_f32_16x16x32_bf16 v[88:91], v[172:175], v[204:207], v[88:91]
    v_mfma_f32_16x16x32_bf16 v[84:87], v[172:175], v[200:203], v[84:87]
    v_max3_f32 v232, v176, v177, v178
    v_max3_f32 v233, v180, v181, v182
    v_max3_f32 v234, v184, v185, v186
    v_max3_f32 v232, v179, v188, v232
    v_max3_f32 v233, v183, v192, v233
    v_max3_f32 v234, v187, v196, v234
    v_max3_f32 v232, v189, v190, v232
    v_max3_f32 v233, v193, v194, v233
    v_max3_f32 v234, v197, v198, v234
    v_max_f32 v232, v191, v232
    v_max_f32 v233, v195, v233
    v_max_f32 v234, v199, v234
    v_mov_b32 v235, v232
    v_mov_b32 v236, v233
    v_mov_b32 v237, v234
    v_permlane32_swap_b32 v232, v235
    v_permlane32_swap_b32 v233, v236
    v_permlane32_swap_b32 v234, v237
    v_max_f32 v232, v232, v235
    v_max_f32 v233, v233, v236
    v_max_f32 v234, v234, v237
    v_mov_b32 v235, v232
    v_mov_b32 v236, v233
    v_mov_b32 v237, v234
    v_permlane16_swap_b32 v232, v235
    v_permlane16_swap_b32 v233, v236
    v_permlane16_swap_b32 v234, v237
    v_max_f32 v232, v232, v235
    v_max_f32 v233, v233, v236
    v_max_f32 v234, v234, v237
    v_max_f32 v232, 0, v232
    v_max_f32 v233, 0, v233
    v_max_f32 v234, 0, v234
    v_sub_f32 v176, v176, v232
    v_sub_f32 v177, v177, v232
    v_sub_f32 v178, v178, v232
    v_sub_f32 v179, v179, v232
    v_sub_f32 v180, v180, v233
    v_sub_f32 v181, v181, v233
    v_sub_f32 v182, v182, v233
    v_sub_f32 v183, v183, v233
    v_sub_f32 v184, v184, v234
    v_sub_f32 v185, v185, v234
    v_sub_f32 v186, v186, v234
    v_sub_f32 v187, v187, v234
    v_sub_f32 v188, v188, v232
    v_sub_f32 v189, v189, v232
    v_sub_f32 v190, v190, v232
    v_sub_f32 v191, v191, v232
    v_sub_f32 v192, v192, v233
    v_sub_f32 v193, v193, v233
    v_sub_f32 v194, v194, v233
    v_sub_f32 v195, v195, v233
    v_sub_f32 v196, v196, v234
    v_sub_f32 v197, v197, v234
    v_sub_f32 v198, v198, v234
    v_sub_f32 v199, v199, v234
    v_exp_f32 v238, -v232
    v_exp_f32 v239, -v233
    v_exp_f32 v240, -v234
    v_sub_f32 v212, v212, v232
    v_sub_f32 v213, v213, v232
    v_sub_f32 v214, v214, v232
    v_sub_f32 v215, v215, v232
    v_sub_f32 v216, v216, v233
    v_sub_f32 v217, v217, v233
    v_sub_f32 v218, v218, v233
    v_sub_f32 v219, v219, v233
    v_sub_f32 v220, v220, v234
    v_sub_f32 v221, v221, v234
    v_sub_f32 v222, v222, v234
    v_sub_f32 v223, v223, v234
    v_mul_f32 v224, v224, v238
    v_mul_f32 v225, v225, v238
    v_mul_f32 v226, v226, v239
    v_mul_f32 v227, v227, v239
    v_mul_f32 v228, v228, v240
    v_mul_f32 v229, v229, v240
    v_mul_f32 v0, v0, v238
    v_mul_f32 v1, v1, v238
    v_mul_f32 v2, v2, v238
    v_mul_f32 v3, v3, v238
    v_mul_f32 v4, v4, v239
    v_mul_f32 v5, v5, v239
    v_mul_f32 v6, v6, v239
    v_mul_f32 v7, v7, v239
    v_mul_f32 v8, v8, v240
    v_mul_f32 v9, v9, v240
    v_mul_f32 v10, v10, v240
    v_mul_f32 v11, v11, v240
    v_mul_f32 v12, v12, v238
    v_mul_f32 v13, v13, v238
    v_mul_f32 v14, v14, v238
    v_mul_f32 v15, v15, v238
    v_mul_f32 v16, v16, v239
    v_mul_f32 v17, v17, v239
    v_mul_f32 v18, v18, v239
    v_mul_f32 v19, v19, v239
    v_mul_f32 v20, v20, v240
    v_mul_f32 v21, v21, v240
    v_mul_f32 v22, v22, v240
    v_mul_f32 v23, v23, v240
    v_mul_f32 v24, v24, v238
    v_mul_f32 v25, v25, v238
    v_mul_f32 v26, v26, v238
    v_mul_f32 v27, v27, v238
    v_mul_f32 v28, v28, v239
    v_mul_f32 v29, v29, v239
    v_mul_f32 v30, v30, v239
    v_mul_f32 v31, v31, v239
    v_mul_f32 v32, v32, v240
    v_mul_f32 v33, v33, v240
    v_mul_f32 v34, v34, v240
    v_mul_f32 v35, v35, v240
    v_mul_f32 v36, v36, v238
    v_mul_f32 v37, v37, v238
    v_mul_f32 v38, v38, v238
    v_mul_f32 v39, v39, v238
    v_mul_f32 v40, v40, v239
    v_mul_f32 v41, v41, v239
    v_mul_f32 v42, v42, v239
    v_mul_f32 v43, v43, v239
    v_mul_f32 v44, v44, v240
    v_mul_f32 v45, v45, v240
    v_mul_f32 v46, v46, v240
    v_mul_f32 v47, v47, v240
    v_mul_f32 v48, v48, v238
    v_mul_f32 v49, v49, v238
    v_mul_f32 v50, v50, v238
    v_mul_f32 v51, v51, v238
    v_mul_f32 v52, v52, v239
    v_mul_f32 v53, v53, v239
    v_mul_f32 v54, v54, v239
    v_mul_f32 v55, v55, v239
    v_mul_f32 v56, v56, v240
    v_mul_f32 v57, v57, v240
    v_mul_f32 v58, v58, v240
    v_mul_f32 v59, v59, v240
    v_mul_f32 v60, v60, v238
    v_mul_f32 v61, v61, v238
    v_mul_f32 v62, v62, v238
    v_mul_f32 v63, v63, v238
    v_mul_f32 v64, v64, v239
    v_mul_f32 v65, v65, v239
    v_mul_f32 v66, v66, v239
    v_mul_f32 v67, v67, v239
    v_mul_f32 v68, v68, v240
    v_mul_f32 v69, v69, v240
    v_mul_f32 v70, v70, v240
    v_mul_f32 v71, v71, v240
    v_mul_f32 v72, v72, v238
    v_mul_f32 v73, v73, v238
    v_mul_f32 v74, v74, v238
    v_mul_f32 v75, v75, v238
    v_mul_f32 v76, v76, v239
    v_mul_f32 v77, v77, v239
    v_mul_f32 v78, v78, v239
    v_mul_f32 v79, v79, v239
    v_mul_f32 v80, v80, v240
    v_mul_f32 v81, v81, v240
    v_mul_f32 v82, v82, v240
    v_mul_f32 v83, v83, v240
    v_mul_f32 v84, v84, v238
    v_mul_f32 v85, v85, v238
    v_mul_f32 v86, v86, v238
    v_mul_f32 v87, v87, v238
    v_mul_f32 v88, v88, v239
    v_mul_f32 v89, v89, v239
    v_mul_f32 v90, v90, v239
    v_mul_f32 v91, v91, v239
    v_mul_f32 v92, v92, v240
    v_mul_f32 v93, v93, v240
    v_mul_f32 v94, v94, v240
    v_mul_f32 v95, v95, v240
    v_exp_f32 v176, v176
    v_exp_f32 v177, v177
    v_exp_f32 v180, v180
    v_exp_f32 v181, v181
    v_exp_f32 v184, v184
    v_exp_f32 v185, v185
    v_exp_f32 v178, v178
    v_exp_f32 v179, v179
    v_exp_f32 v182, v182
    v_exp_f32 v183, v183
    v_exp_f32 v186, v186
    v_exp_f32 v187, v187
    v_exp_f32 v188, v188
    v_exp_f32 v189, v189
    v_exp_f32 v192, v192
    v_exp_f32 v193, v193
    v_exp_f32 v196, v196
    v_exp_f32_e64 v197, v197
    s_cmp_lg_u32 s64, 0
    s_branch L_back_0
L_up_1:
    s_waitcnt lgkmcnt(0)
    v_mfma_f32_16x16x32_bf16 v[24:27], v[152:155], v[200:203], v[24:27]
    v_mfma_f32_16x16x32_bf16 v[28:31], v[152:155], v[204:207], v[28:31]
    v_mfma_f32_16x16x32_bf16 v[32:35], v[152:155], v[208:211], v[32:35]
    v_mfma_f32_16x16x32_bf16 v[44:47], v[156:159], v[208:211], v[44:47]
    v_mfma_f32_16x16x32_bf16 v[40:43], v[156:159], v[204:207], v[40:43]
    v_mfma_f32_16x16x32_bf16 v[36:39], v[156:159], v[200:203], v[36:39]
    v_mfma_f32_16x16x32_bf16 v[48:51], v[160:163], v[200:203], v[48:51]
    v_mfma_f32_16x16x32_bf16 v[52:55], v[160:163], v[204:207], v[52:55]
    v_mfma_f32_16x16x32_bf16 v[56:59], v[160:163], v[208:211], v[56:59]
    v_mfma_f32_16x16x32_bf16 v[68:71], v[164:167], v[208:211], v[68:71]
    v_mfma_f32_16x16x32_bf16 v[64:67], v[164:167], v[204:207], v[64:67]
    v_mfma_f32_16x16x32_bf16 v[60:63], v[164:167], v[200:203], v[60:63]
    v_mfma_f32_16x16x32_bf16 v[72:75], v[168:171], v[200:203], v[72:75]
    v_mfma_f32_16x16x32_bf16 v[76:79], v[168:171], v[204:207], v[76:79]
    v_mfma_f32_16x16x32_bf16 v[80:83], v[168:171], v[208:211], v[80:83]
    v_mfma_f32_16x16x32_bf16 v[92:95], v[172:175], v[208:211], v[92:95]
    v_mfma_f32_16x16x32_bf16 v[88:91], v[172:175], v[204:207], v[88:91]
    v_mfma_f32_16x16x32_bf16 v[84:87], v[172:175], v[200:203], v[84:87]
    v_max3_f32 v232, v176, v177, v178
    v_max3_f32 v233, v180, v181, v182
    v_max3_f32 v234, v184, v185, v186
    v_max3_f32 v232, v179, v188, v232
    v_max3_f32 v233, v183, v192, v233
    v_max3_f32 v234, v187, v196, v234
    v_max3_f32 v232, v189, v190, v232
    v_max3_f32 v233, v193, v194, v233
    v_max3_f32 v234, v197, v198, v234
    v_max_f32 v232, v191, v232
    v_max_f32 v233, v195, v233
    v_max_f32 v234, v199, v234
    v_mov_b32 v235, v232
    v_mov_b32 v236, v233
    v_mov_b32 v237, v234
    v_permlane32_swap_b32 v232, v235
    v_permlane32_swap_b32 v233, v236
    v_permlane32_swap_b32 v234, v237
    v_max_f32 v232, v232, v235
    v_max_f32 v233, v233, v236
    v_max_f32 v234, v234, v237
    v_mov_b32 v235, v232
    v_mov_b32 v236, v233
    v_mov_b32 v237, v234
    v_permlane16_swap_b32 v232, v235
    v_permlane16_swap_b32 v233, v236
    v_permlane16_swap_b32 v234, v237
    v_max_f32 v232, v232, v235
    v_max_f32 v233, v233, v236
    v_max_f32 v234, v234, v237
    v_max_f32 v232, 0, v232
    v_max_f32 v233, 0, v233
    v_max_f32 v234, 0, v234
    v_sub_f32 v176, v176, v232
    v_sub_f32 v177, v177, v232
    v_sub_f32 v178, v178, v232
    v_sub_f32 v179, v179, v232
    v_sub_f32 v180, v180, v233
    v_sub_f32 v181, v181, v233
    v_sub_f32 v182, v182, v233
    v_sub_f32 v183, v183, v233
    v_sub_f32 v184, v184, v234
    v_sub_f32 v185, v185, v234
    v_sub_f32 v186, v186, v234
    v_sub_f32 v187, v187, v234
    v_sub_f32 v188, v188, v232
    v_sub_f32 v189, v189, v232
    v_sub_f32 v190, v190, v232
    v_sub_f32 v191, v191, v232
    v_sub_f32 v192, v192, v233
    v_sub_f32 v193, v193, v233
    v_sub_f32 v194, v194, v233
    v_sub_f32 v195, v195, v233
    v_sub_f32 v196, v196, v234
    v_sub_f32 v197, v197, v234
    v_sub_f32 v198, v198, v234
    v_sub_f32 v199, v199, v234
    v_exp_f32 v238, -v232
    v_exp_f32 v239, -v233
    v_exp_f32 v240, -v234
    v_sub_f32 v212, v212, v232
    v_sub_f32 v213, v213, v232
    v_sub_f32 v214, v214, v232
    v_sub_f32 v215, v215, v232
    v_sub_f32 v216, v216, v233
    v_sub_f32 v217, v217, v233
    v_sub_f32 v218, v218, v233
    v_sub_f32 v219, v219, v233
    v_sub_f32 v220, v220, v234
    v_sub_f32 v221, v221, v234
    v_sub_f32 v222, v222, v234
    v_sub_f32 v223, v223, v234
    v_mul_f32 v224, v224, v238
    v_mul_f32 v225, v225, v238
    v_mul_f32 v226, v226, v239
    v_mul_f32 v227, v227, v239
    v_mul_f32 v228, v228, v240
    v_mul_f32 v229, v229, v240
    v_mul_f32 v0, v0, v238
    v_mul_f32 v1, v1, v238
    v_mul_f32 v2, v2, v238
    v_mul_f32 v3, v3, v238
    v_mul_f32 v4, v4, v239
    v_mul_f32 v5, v5, v239
    v_mul_f32 v6, v6, v239
    v_mul_f32 v7, v7, v239
    v_mul_f32 v8, v8, v240
    v_mul_f32 v9, v9, v240
    v_mul_f32 v10, v10, v240
    v_mul_f32 v11, v11, v240
    v_mul_f32 v12, v12, v238
    v_mul_f32 v13, v13, v238
    v_mul_f32 v14, v14, v238
    v_mul_f32 v15, v15, v238
    v_mul_f32 v16, v16, v239
    v_mul_f32 v17, v17, v239
    v_mul_f32 v18, v18, v239
    v_mul_f32 v19, v19, v239
    v_mul_f32 v20, v20, v240
    v_mul_f32 v21, v21, v240
    v_mul_f32 v22, v22, v240
    v_mul_f32 v23, v23, v240
    v_mul_f32 v24, v24, v238
    v_mul_f32 v25, v25, v238
    v_mul_f32 v26, v26, v238
    v_mul_f32 v27, v27, v238
    v_mul_f32 v28, v28, v239
    v_mul_f32 v29, v29, v239
    v_mul_f32 v30, v30, v239
    v_mul_f32 v31, v31, v239
    v_mul_f32 v32, v32, v240
    v_mul_f32 v33, v33, v240
    v_mul_f32 v34, v34, v240
    v_mul_f32 v35, v35, v240
    v_mul_f32 v36, v36, v238
    v_mul_f32 v37, v37, v238
    v_mul_f32 v38, v38, v238
    v_mul_f32 v39, v39, v238
    v_mul_f32 v40, v40, v239
    v_mul_f32 v41, v41, v239
    v_mul_f32 v42, v42, v239
    v_mul_f32 v43, v43, v239
    v_mul_f32 v44, v44, v240
    v_mul_f32 v45, v45, v240
    v_mul_f32 v46, v46, v240
    v_mul_f32 v47, v47, v240
    v_mul_f32 v48, v48, v238
    v_mul_f32 v49, v49, v238
    v_mul_f32 v50, v50, v238
    v_mul_f32 v51, v51, v238
    v_mul_f32 v52, v52, v239
    v_mul_f32 v53, v53, v239
    v_mul_f32 v54, v54, v239
    v_mul_f32 v55, v55, v239
    v_mul_f32 v56, v56, v240
    v_mul_f32 v57, v57, v240
    v_mul_f32 v58, v58, v240
    v_mul_f32 v59, v59, v240
    v_mul_f32 v60, v60, v238
    v_mul_f32 v61, v61, v238
    v_mul_f32 v62, v62, v238
    v_mul_f32 v63, v63, v238
    v_mul_f32 v64, v64, v239
    v_mul_f32 v65, v65, v239
    v_mul_f32 v66, v66, v239
    v_mul_f32 v67, v67, v239
    v_mul_f32 v68, v68, v240
    v_mul_f32 v69, v69, v240
    v_mul_f32 v70, v70, v240
    v_mul_f32 v71, v71, v240
    v_mul_f32 v72, v72, v238
    v_mul_f32 v73, v73, v238
    v_mul_f32 v74, v74, v238
    v_mul_f32 v75, v75, v238
    v_mul_f32 v76, v76, v239
    v_mul_f32 v77, v77, v239
    v_mul_f32 v78, v78, v239
    v_mul_f32 v79, v79, v239
    v_mul_f32 v80, v80, v240
    v_mul_f32 v81, v81, v240
    v_mul_f32 v82, v82, v240
    v_mul_f32 v83, v83, v240
    v_mul_f32 v84, v84, v238
    v_mul_f32 v85, v85, v238
    v_mul_f32 v86, v86, v238
    v_mul_f32 v87, v87, v238
    v_mul_f32 v88, v88, v239
    v_mul_f32 v89, v89, v239
    v_mul_f32 v90, v90, v239
    v_mul_f32 v91, v91, v239
    v_mul_f32 v92, v92, v240
    v_mul_f32 v93, v93, v240
    v_mul_f32 v94, v94, v240
    v_mul_f32 v95, v95, v240
    v_exp_f32 v176, v176
    v_exp_f32 v177, v177
    v_exp_f32 v180, v180
    v_exp_f32 v181, v181
    v_exp_f32 v184, v184
    v_exp_f32 v185, v185
    v_exp_f32 v178, v178
    v_exp_f32 v179, v179
    v_exp_f32 v182, v182
    v_exp_f32 v183, v183
    v_exp_f32 v186, v186
    v_exp_f32 v187, v187
    v_exp_f32 v188, v188
    v_exp_f32 v189, v189
    v_exp_f32 v192, v192
    v_exp_f32 v193, v193
    v_exp_f32 v196, v196
    v_exp_f32_e64 v197, v197
    s_cmp_lg_u32 s64, 0
    s_branch L_back_1
L_up_2:
    s_waitcnt lgkmcnt(0)
    v_mfma_f32_16x16x32_bf16 v[24:27], v[152:155], v[200:203], v[24:27]
    v_mfma_f32_16x16x32_bf16 v[28:31], v[152:155], v[204:207], v[28:31]
    v_mfma_f32_16x16x32_bf16 v[32:35], v[152:155], v[208:211], v[32:35]
    v_mfma_f32_16x16x32_bf16 v[44:47], v[156:159], v[208:211], v[44:47]
    v_mfma_f32_16x16x32_bf16 v[40:43], v[156:159], v[204:207], v[40:43]
    v_mfma_f32_16x16x32_bf16 v[36:39], v[156:159], v[200:203], v[36:39]
    v_mfma_f32_16x16x32_bf16 v[48:51], v[160:163], v[200:203], v[48:51]
    v_mfma_f32_16x16x32_bf16 v[52:55], v[160:163], v[204:207], v[52:55]
    v_mfma_f32_16x16x32_bf16 v[56:59], v[160:163], v[208:211], v[56:59]
    v_mfma_f32_16x16x32_bf16 v[68:71], v[164:167], v[208:211], v[68:71]
    v_mfma_f32_16x16x32_bf16 v[64:67], v[164:167], v[204:207], v[64:67]
    v_mfma_f32_16x16x32_bf16 v[60:63], v[164:167], v[200:203], v[60:63]
    v_mfma_f32_16x16x32_bf16 v[72:75], v[168:171], v[200:203], v[72:75]
    v_mfma_f32_16x16x32_bf16 v[76:79], v[168:171], v[204:207], v[76:79]
    v_mfma_f32_16x16x32_bf16 v[80:83], v[168:171], v[208:211], v[80:83]
    v_mfma_f32_16x16x32_bf16 v[92:95], v[172:175], v[208:211], v[92:95]
    v_mfma_f32_16x16x32_bf16 v[88:91], v[172:175], v[204:207], v[88:91]
    v_mfma_f32_16x16x32_bf16 v[84:87], v[172:175], v[200:203], v[84:87]
    v_max3_f32 v232, v176, v177, v178
    v_max3_f32 v233, v180, v181, v182
    v_max3_f32 v234, v184, v185, v186
    v_max3_f32 v232, v179, v188, v232
    v_max3_f32 v233, v183, v192, v233
    v_max3_f32 v234, v187, v196, v234
    v_max3_f32 v232, v189, v190, v232
    v_max3_f32 v233, v193, v194, v233
    v_max3_f32 v234, v197, v198, v234
    v_max_f32 v232, v191, v232
    v_max_f32 v233, v195, v233
    v_max_f32 v234, v199, v234
    v_mov_b32 v235, v232
    v_mov_b32 v236, v233
    v_mov_b32 v237, v234
    v_permlane32_swap_b32 v232, v235
    v_permlane32_swap_b32 v233, v236
    v_permlane32_swap_b32 v234, v237
    v_max_f32 v232, v232, v235
    v_max_f32 v233, v233, v236
    v_max_f32 v234, v234, v237
    v_mov_b32 v235, v232
    v_mov_b32 v236, v233
    v_mov_b32 v237, v234
    v_permlane16_swap_b32 v232, v235
    v_permlane16_swap_b32 v233, v236
    v_permlane16_swap_b32 v234, v237
    v_max_f32 v232, v232, v235
    v_max_f32 v233, v233, v236
    v_max_f32 v234, v234, v237
    v_max_f32 v232, 0, v232
    v_max_f32 v233, 0, v233
    v_max_f32 v234, 0, v234
    v_sub_f32 v176, v176, v232
    v_sub_f32 v177, v177, v232
    v_sub_f32 v178, v178, v232
    v_sub_f32 v179, v179, v232
    v_sub_f32 v180, v180, v233
    v_sub_f32 v181, v181, v233
    v_sub_f32 v182, v182, v233
    v_sub_f32 v183, v183, v233
    v_sub_f32 v184, v184, v234
    v_sub_f32 v185, v185, v234
    v_sub_f32 v186, v186, v234
    v_sub_f32 v187, v187, v234
    v_sub_f32 v188, v188, v232
    v_sub_f32 v189, v189, v232
    v_sub_f32 v190, v190, v232
    v_sub_f32 v191, v191, v232
    v_sub_f32 v192, v192, v233
    v_sub_f32 v193, v193, v233
    v_sub_f32 v194, v194, v233
    v_sub_f32 v195, v195, v233
    v_sub_f32 v196, v196, v234
    v_sub_f32 v197, v197, v234
    v_sub_f32 v198, v198, v234
    v_sub_f32 v199, v199, v234
    v_exp_f32 v238, -v232
    v_exp_f32 v239, -v233
    v_exp_f32 v240, -v234
    v_sub_f32 v212, v212, v232
    v_sub_f32 v213, v213, v232
    v_sub_f32 v214, v214, v232
    v_sub_f32 v215, v215, v232
    v_sub_f32 v216, v216, v233
    v_sub_f32 v217, v217, v233
    v_sub_f32 v218, v218, v233
    v_sub_f32 v219, v219, v233
    v_sub_f32 v220, v220, v234
    v_sub_f32 v221, v221, v234
    v_sub_f32 v222, v222, v234
    v_sub_f32 v223, v223, v234
    v_mul_f32 v224, v224, v238
    v_mul_f32 v225, v225, v238
    v_mul_f32 v226, v226, v239
    v_mul_f32 v227, v227, v239
    v_mul_f32 v228, v228, v240
    v_mul_f32 v229, v229, v240
    v_mul_f32 v0, v0, v238
    v_mul_f32 v1, v1, v238
    v_mul_f32 v2, v2, v238
    v_mul_f32 v3, v3, v238
    v_mul_f32 v4, v4, v239
    v_mul_f32 v5, v5, v239
    v_mul_f32 v6, v6, v239
    v_mul_f32 v7, v7, v239
    v_mul_f32 v8, v8, v240
    v_mul_f32 v9, v9, v240
    v_mul_f32 v10, v10, v240
    v_mul_f32 v11, v11, v240
    v_mul_f32 v12, v12, v238
    v_mul_f32 v13, v13, v238
    v_mul_f32 v14, v14, v238
    v_mul_f32 v15, v15, v238
    v_mul_f32 v16, v16, v239
    v_mul_f32 v17, v17, v239
    v_mul_f32 v18, v18, v239
    v_mul_f32 v19, v19, v239
    v_mul_f32 v20, v20, v240
    v_mul_f32 v21, v21, v240
    v_mul_f32 v22, v22, v240
    v_mul_f32 v23, v23, v240
    v_mul_f32 v24, v24, v238
    v_mul_f32 v25, v25, v238
    v_mul_f32 v26, v26, v238
    v_mul_f32 v27, v27, v238
    v_mul_f32 v28, v28, v239
    v_mul_f32 v29, v29, v239
    v_mul_f32 v30, v30, v239
    v_mul_f32 v31, v31, v239
    v_mul_f32 v32, v32, v240
    v_mul_f32 v33, v33, v240
    v_mul_f32 v34, v34, v240
    v_mul_f32 v35, v35, v240
    v_mul_f32 v36, v36, v238
    v_mul_f32 v37, v37, v238
    v_mul_f32 v38, v38, v238
    v_mul_f32 v39, v39, v238
    v_mul_f32 v40, v40, v239
    v_mul_f32 v41, v41, v239
    v_mul_f32 v42, v42, v239
    v_mul_f32 v43, v43, v239
    v_mul_f32 v44, v44, v240
    v_mul_f32 v45, v45, v240
    v_mul_f32 v46, v46, v240
    v_mul_f32 v47, v47, v240
    v_mul_f32 v48, v48, v238
    v_mul_f32 v49, v49, v238
    v_mul_f32 v50, v50, v238
    v_mul_f32 v51, v51, v238
    v_mul_f32 v52, v52, v239
    v_mul_f32 v53, v53, v239
    v_mul_f32 v54, v54, v239
    v_mul_f32 v55, v55, v239
    v_mul_f32 v56, v56, v240
    v_mul_f32 v57, v57, v240
    v_mul_f32 v58, v58, v240
    v_mul_f32 v59, v59, v240
    v_mul_f32 v60, v60, v238
    v_mul_f32 v61, v61, v238
    v_mul_f32 v62, v62, v238
    v_mul_f32 v63, v63, v238
    v_mul_f32 v64, v64, v239
    v_mul_f32 v65, v65, v239
    v_mul_f32 v66, v66, v239
    v_mul_f32 v67, v67, v239
    v_mul_f32 v68, v68, v240
    v_mul_f32 v69, v69, v240
    v_mul_f32 v70, v70, v240
    v_mul_f32 v71, v71, v240
    v_mul_f32 v72, v72, v238
    v_mul_f32 v73, v73, v238
    v_mul_f32 v74, v74, v238
    v_mul_f32 v75, v75, v238
    v_mul_f32 v76, v76, v239
    v_mul_f32 v77, v77, v239
    v_mul_f32 v78, v78, v239
    v_mul_f32 v79, v79, v239
    v_mul_f32 v80, v80, v240
    v_mul_f32 v81, v81, v240
    v_mul_f32 v82, v82, v240
    v_mul_f32 v83, v83, v240
    v_mul_f32 v84, v84, v238
    v_mul_f32 v85, v85, v238
    v_mul_f32 v86, v86, v238
    v_mul_f32 v87, v87, v238
    v_mul_f32 v88, v88, v239
    v_mul_f32 v89, v89, v239
    v_mul_f32 v90, v90, v239
    v_mul_f32 v91, v91, v239
    v_mul_f32 v92, v92, v240
    v_mul_f32 v93, v93, v240
    v_mul_f32 v94, v94, v240
    v_mul_f32 v95, v95, v240
    v_exp_f32 v176, v176
    v_exp_f32 v177, v177
    v_exp_f32 v180, v180
    v_exp_f32 v181, v181
    v_exp_f32 v184, v184
    v_exp_f32 v185, v185
    v_exp_f32 v178, v178
    v_exp_f32 v179, v179
    v_exp_f32 v182, v182
    v_exp_f32 v183, v183
    v_exp_f32 v186, v186
    v_exp_f32 v187, v187
    v_exp_f32 v188, v188
    v_exp_f32 v189, v189
    v_exp_f32 v192, v192
    v_exp_f32 v193, v193
    v_exp_f32 v196, v196
    v_exp_f32_e64 v197, v197
    s_cmp_lg_u32 s64, 0
    s_branch L_back_2
L_far:
    s_waitcnt lgkmcnt(12)
    v_mfma_f32_16x16x32_bf16 v[0:3], v[144:147], v[200:203], v[0:3]
    v_mfma_f32_16x16x32_bf16 v[4:7], v[144:147], v[204:207], v[4:7]
    v_mfma_f32_16x16x32_bf16 v[8:11], v[144:147], v[208:211], v[8:11]
    v_mfma_f32_16x16x32_bf16 v[20:23], v[148:151], v[208:211], v[20:23]
    v_mfma_f32_16x16x32_bf16 v[16:19], v[148:151], v[204:207], v[16:19]
    v_mfma_f32_16x16x32_bf16 v[12:15], v[148:151], v[200:203], v[12:15]
    s_waitcnt lgkmcnt(10)
    v_mfma_f32_16x16x32_bf16 v[24:27], v[152:155], v[200:203], v[24:27]
    s_nop 0
    v_cvt_pk_bf16_f32 v96, v0, v1
    v_cvt_pk_bf16_f32 v97, v2, v3
    v_mfma_f32_16x16x32_bf16 v[28:31], v[152:155], v[204:207], v[28:31]
    v_cvt_pk_bf16_f32 v100, v4, v5
    v_cvt_pk_bf16_f32 v101, v6, v7
    v_mfma_f32_16x16x32_bf16 v[32:35], v[152:155], v[208:211], v[32:35]
    v_cvt_pk_bf16_f32 v104, v8, v9
    v_cvt_pk_bf16_f32 v105, v10, v11
    s_waitcnt lgkmcnt(8)
    v_mfma_f32_16x16x32_bf16 v[44:47], v[156:159], v[208:211], v[44:47]
    v_cvt_pk_bf16_f32 v98, v12, v13
    v_cvt_pk_bf16_f32 v99, v14, v15
    v_mfma_f32_16x16x32_bf16 v[40:43], v[156:159], v[204:207], v[40:43]
    v_cvt_pk_bf16_f32 v102, v16, v17
    v_cvt_pk_bf16_f32 v103, v18, v19
    v_mfma_f32_16x16x32_bf16 v[36:39], v[156:159], v[200:203], v[36:39]
    v_cvt_pk_bf16_f32 v106, v20, v21
    v_cvt_pk_bf16_f32 v107, v22, v23
    s_waitcnt lgkmcnt(6)
    v_mfma_f32_16x16x32_bf16 v[48:51], v[160:163], v[200:203], v[48:51]
    s_mov_b32 s60, 0
    buffer_store_dwordx4 v[96:99], v241, s[44:47], s60 offen offset:0 sc1
    buffer_store_dwordx4 v[100:103], v241, s[44:47], s60 offen offset:1024 sc1
    buffer_store_dwordx4 v[104:107], v241, s[44:47], s60 offen offset:2048 sc1
    v_cvt_pk_bf16_f32 v108, v24, v25
    v_cvt_pk_bf16_f32 v109, v26, v27
    v_mfma_f32_16x16x32_bf16 v[52:55], v[160:163], v[204:207], v[52:55]
    v_cvt_pk_bf16_f32 v112, v28, v29
    v_cvt_pk_bf16_f32 v113, v30, v31
    v_mfma_f32_16x16x32_bf16 v[56:59], v[160:163], v[208:211], v[56:59]
    v_cvt_pk_bf16_f32 v116, v32, v33
    v_cvt_pk_bf16_f32 v117, v34, v35
    s_waitcnt lgkmcnt(4)
    v_mfma_f32_16x16x32_bf16 v[68:71], v[164:167], v[208:211], v[68:71]
    v_cvt_pk_bf16_f32 v110, v36, v37
    v_cvt_pk_bf16_f32 v111, v38, v39
    v_mfma_f32_16x16x32_bf16 v[64:67], v[164:167], v[204:207], v[64:67]
    v_cvt_pk_bf16_f32 v114, v40, v41
    v_cvt_pk_bf16_f32 v115, v42, v43
    v_mfma_f32_16x16x32_bf16 v[60:63], v[164:167], v[200:203], v[60:63]
    v_cvt_pk_bf16_f32 v118, v44, v45
    v_cvt_pk_bf16_f32 v119, v46, v47
    s_waitcnt lgkmcnt(2)
    v_mfma_f32_16x16x32_bf16 v[72:75], v[168:171], v[200:203], v[72:75]
    s_mov_b32 s60, 3072
    buffer_store_dwordx4 v[108:111], v241, s[44:47], s60 offen offset:0 sc1
    buffer_store_dwordx4 v[112:115], v241, s[44:47], s60 offen offset:1024 sc1
    buffer_store_dwordx4 v[116:119], v241, s[44:47], s60 offen offset:2048 sc1
    v_cvt_pk_bf16_f32 v120, v48, v49
    v_cvt_pk_bf16_f32 v121, v50, v51
    v_mfma_f32_16x16x32_bf16 v[76:79], v[168:171], v[204:207], v[76:79]
    v_cvt_pk_bf16_f32 v124, v52, v53
    v_cvt_pk_bf16_f32 v125, v54, v55
    v_mfma_f32_16x16x32_bf16 v[80:83], v[168:171], v[208:211], v[80:83]
    v_cvt_pk_bf16_f32 v128, v56, v57
    v_cvt_pk_bf16_f32 v129, v58, v59
    s_waitcnt lgkmcnt(0)
    v_mfma_f32_16x16x32_bf16 v[92:95], v[172:175], v[208:211], v[92:95]
    v_cvt_pk_bf16_f32 v122, v60, v61
    v_cvt_pk_bf16_f32 v123, v62, v63
    v_mfma_f32_16x16x32_bf16 v[88:91], v[172:175], v[204:207], v[88:91]
    v_cvt_pk_bf16_f32 v126, v64, v65
    v_cvt_pk_bf16_f32 v127, v66, v67
    v_mfma_f32_16x16x32_bf16 v[84:87], v[172:175], v[200:203], v[84:87]
    v_cvt_pk_bf16_f32 v130, v68, v69
    v_cvt_pk_bf16_f32 v131, v70, v71
    s_mov_b32 s60, 24576
    buffer_store_dwordx4 v[120:123], v241, s[44:47], s60 offen offset:0 sc1
    buffer_store_dwordx4 v[124:127], v241, s[44:47], s60 offen offset:1024 sc1
    buffer_store_dwordx4 v[128:131], v241, s[44:47], s60 offen offset:2048 sc1
    v_cvt_pk_bf16_f32 v132, v72, v73
    v_cvt_pk_bf16_f32 v133, v74, v75
    v_cvt_pk_bf16_f32 v136, v76, v77
    v_cvt_pk_bf16_f32 v137, v78, v79
    v_cvt_pk_bf16_f32 v140, v80, v81
    v_cvt_pk_bf16_f32 v141, v82, v83
    v_cvt_pk_bf16_f32 v134, v84, v85
    v_cvt_pk_bf16_f32 v135, v86, v87
    v_cvt_pk_bf16_f32 v138, v88, v89
    v_cvt_pk_bf16_f32 v139, v90, v91
    v_cvt_pk_bf16_f32 v142, v92, v93
    v_cvt_pk_bf16_f32 v143, v94, v95
    s_mov_b32 s60, 27648
    buffer_store_dwordx4 v[132:135], v241, s[44:47], s60 offen offset:0 sc1
    buffer_store_dwordx4 v[136:139], v241, s[44:47], s60 offen offset:1024 sc1
    buffer_store_dwordx4 v[140:143], v241, s[44:47], s60 offen offset:2048 sc1
    v_and_b32 v238, 3, v243
    v_xor_b32 v238, s76, v238
    v_lshlrev_b32 v238, 2, v238
    s_mov_b32 s73, 0
L_rechk:
    s_cmp_lg_u32 s74, 2
    s_cbranch_scc1 L_rechk_done
    buffer_load_dword v239, v238, s[48:51], 0 offen sc1
    s_waitcnt vmcnt(0)
    v_lshrrev_b32 v235, 4, v239
    v_and_b32 v235, 0x0f0f0f0f, v235
    v_and_b32 v236, 0x0f0f0f0f, v239
    v_add_u32_e64 v235, v235, v236
    v_sad_u8 v235, v235, 0, 0
    v_readfirstlane_b32 s61, v239
    v_cmp_ne_u32 vcc, 8, v235
    s_lshl_b32 s60, 8, s75
    s_cmp_eq_u32 s60, s61
    s_cselect_b32 s74, 1, 0
    s_cmp_eq_u64 vcc, 0
    s_cselect_b32 s74, s74, 2
    s_add_u32 s73, s73, 1
    s_cmp_lt_u32 s73, 50000
    s_cbranch_scc1 L_rechk
L_rechk_done:
    s_mov_b32 s74, 0
    s_branch L_near
L_farflag:
    buffer_store_dword v242, v231, s[44:47], 0 offen sc1
    s_branch L_flagged
L_text_end:
.section .rodata,"a"
.p2align 6
.amdhsa_kernel concat_heads__mha_block_cached__gqa_block_cached__near_ridge_kernel
  .amdhsa_next_free_vgpr 256
  .amdhsa_next_free_sgpr 102
  .amdhsa_accum_offset 256
  .amdhsa_group_segment_fixed_size 0
  .amdhsa_kernarg_size 104
  .amdhsa_user_sgpr_count 2
  .amdhsa_user_sgpr_kernarg_segment_ptr 1
  .amdhsa_system_sgpr_workgroup_id_x 1
  .amdhsa_float_denorm_mode_32 3
.end_amdhsa_kernel
```
